```python
import torch

def _softmax(x, axis=-1):
    return torch.softmax(x, dim=axis)
def _gelu(x):
    return torch.nn.functional.gelu(x, approximate="tanh")
def _silu(x):
    return torch.nn.functional.silu(x)
def _sigmoid(x):
    return torch.sigmoid(x)
def _layernorm(x, axis=-1, eps=1e-5):
    m = x.mean(dim=axis, keepdim=True)
    v = x.var(dim=axis, keepdim=True, unbiased=False)
    return (x - m) / torch.sqrt(v + eps)
def _scatter_add(tgt, idx, src, axis=0):
    return tgt.clone().index_add_(axis, idx, src)
def _segment_sum(src, seg, n):
    out = torch.zeros((n,) + src.shape[1:], dtype=src.dtype)
    return out.index_add_(0, seg, src)
def _pad(x, pw):
    flat = tuple(v for pair in reversed(pw) for v in pair)
    return torch.nn.functional.pad(x, flat)

kernel_name = 'gated_mix__ssm_conv_s4__dense_activation_squared_relu__prompt'

def setup_inputs():

    _w = (lambda a: (lambda t: t.to(torch.bfloat16) if t.is_floating_point() else t)(torch.as_tensor(a)))
    def _A_setup():
        B, L, D, N = 1, 2048, 512, 128
        A_re = -(lambda _x: torch.exp(torch.as_tensor(_x)))((lambda *s: torch.randn(*s, dtype=torch.bfloat16) * 6.4)(D, N))
        A_im = torch.pi * (lambda *s: torch.randn(*s, dtype=torch.bfloat16) * 0.1)(D, N)
        B_re = (lambda *s: torch.randn(*s, dtype=torch.bfloat16) * 0.2)(D, N)
        B_im = (lambda *s: torch.randn(*s, dtype=torch.bfloat16) * 0.2)(D, N)
        C_re = (lambda *s: torch.randn(*s, dtype=torch.bfloat16) * 0.2)(D, N)
        C_im = (lambda *s: torch.randn(*s, dtype=torch.bfloat16) * 0.2)(D, N)
        log_dt = (lambda *s: torch.randn(*s, dtype=torch.bfloat16) * 0.1)(D) * 0.5 - 4.0
        Dskip = (lambda *s: torch.randn(*s, dtype=torch.bfloat16) * 0.1)(D)
        return {
            "u": _w((lambda *s: torch.randn(*s, dtype=torch.bfloat16) * 0.05)(B, L, D)),
            "A_re": _w(A_re),
            "A_im": _w(A_im),
            "B_re": _w(B_re),
            "B_im": _w(B_im),
            "C_re": _w(C_re),
            "C_im": _w(C_im),
            "log_dt": _w(log_dt),
            "Dskip": _w(Dskip),
        }
    _A_in = _A_setup()

    def _B_setup():
        B, S, D, F = 1, 2048, 512, 1792
        return {
            "x": _w((lambda *s: torch.randn(*s, dtype=torch.bfloat16) * 0.05)(B, S, D)),
            "w1": _w((lambda *s: torch.randn(*s, dtype=torch.bfloat16) * 0.05)(D, F)),
            "b1": _w((lambda *s: torch.randn(*s, dtype=torch.bfloat16) * 0.05)(F)),
            "w2": _w((lambda *s: torch.randn(*s, dtype=torch.bfloat16) * 0.05)(F, D)),
            "b2": _w((lambda *s: torch.randn(*s, dtype=torch.bfloat16) * 0.05)(D)),
        }
    _B_in = _B_setup()

    return {
        "A_u": _A_in["u"],
        "A_A_re": _A_in["A_re"],
        "A_A_im": _A_in["A_im"],
        "A_B_re": _A_in["B_re"],
        "A_B_im": _A_in["B_im"],
        "A_C_re": _A_in["C_re"],
        "A_C_im": _A_in["C_im"],
        "A_log_dt": _A_in["log_dt"],
        "A_Dskip": _A_in["Dskip"],
        "B_x": _B_in["x"],
        "B_w1": _B_in["w1"],
        "B_b1": _B_in["b1"],
        "B_w2": _B_in["w2"],
        "B_b2": _B_in["b2"],
        "gate_w": _w((lambda *s: torch.randn(*s, dtype=torch.bfloat16) * 0.05)(512) * 16.0),
    }

def reference(A_u, A_A_re, A_A_im, A_B_re, A_B_im, A_C_re, A_C_im, A_log_dt, A_Dskip, B_x, B_w1, B_b1, B_w2, B_b2, gate_w):
    def _A_ref(u, A_re, A_im, B_re, B_im, C_re, C_im, log_dt, Dskip):
        Bsz, L, D = u.shape
        dt = torch.exp(log_dt)[:, None]
        A = A_re + 1j * A_im
        Bc = B_re + 1j * B_im
        Cc = C_re + 1j * C_im
        logdA = dt * A
        dB = dt * Bc
        l = (lambda x, dt: x.to(dt))(torch.arange(L), A_re.dtype)
        P = torch.exp(logdA[:, :, None] * l[None, None, :])
        K = torch.einsum("dn,dnl,dn->dl", Cc, P, dB).real
        L2 = 2 * L
        Kp = _pad(K, ((0, 0), (0, L)))
        up = (lambda x, *d: x.permute(*d))(u, 0, 2, 1)
        up = _pad(up, ((0, 0), (0, 0), (0, L)))
        Kf = (lambda x, axes=(-2,-1): torch.fft.rfft2(x.float(), dim=axes))(Kp[:, None, :], axes=(-2, -1))
        Uf = (lambda x, axes=(-2,-1): torch.fft.rfft2(x.float(), dim=axes))(up[:, :, None, :], axes=(-2, -1))
        Yf = Uf * Kf[None, :, :, :]
        y = (lambda x, s, axes=(-2,-1): torch.fft.irfft2(x, s=s, dim=axes).to(torch.bfloat16))(Yf, (1, L2), axes=(-2, -1))[:, :, 0, :L]
        y = (lambda x, *d: x.permute(*d))(y, 0, 2, 1) + u * Dskip[None, None, :]
        return y

    def _B_ref(x, w1, b1, w2, b2):
        h = torch.einsum("bsd,df->bsf", x, w1) + b1
        zero = torch.zeros_like(h)
        r = torch.where(h > zero, h, zero)
        h = r * r
        out = torch.einsum("bsf,fd->bsd", h, w2) + b2
        return out

    x = A_u
    g = _sigmoid((x * gate_w).sum(-1, keepdims=True))
    a = _A_ref(x, A_A_re, A_A_im, A_B_re, A_B_im, A_C_re, A_C_im, A_log_dt, A_Dskip)
    b = _B_ref(x, B_w1, B_b1, B_w2, B_b2)
    return g * a + (1 - g) * b
```

```asm
; @launch grid=(256,1,1) block=(512,1,1) lds=163840
.amdgcn_target "amdgcn-amd-amdhsa--gfx950"
.text
.globl gated_mix__ssm_conv_s4__dense_activation_squared_relu__prompt_kernel
.p2align 8
.type gated_mix__ssm_conv_s4__dense_activation_squared_relu__prompt_kernel,@function
gated_mix__ssm_conv_s4__dense_activation_squared_relu__prompt_kernel:
    s_cmp_ge_u32 s2, 256
    s_cbranch_scc1 L_end
    s_nop 0
    s_load_dwordx16 s[8:23], s[0:1], 0
    s_load_dwordx16 s[24:39], s[0:1], 64
    s_load_dwordx4 s[40:43], s[0:1], 128
    v_lshrrev_b32 v1, 6, v0
    v_and_b32 v0, 63, v0
    v_readfirstlane_b32 s68, v1
    s_and_b32 s69, s2, 7
    s_lshr_b32 s70, s2, 3
    s_lshr_b32 s71, s70, 4
    s_lshl_b32 s73, s69, 1
    s_add_u32 s71, s71, s73
    s_and_b32 s72, s70, 15
    s_and_b32 s96, s68, 3
    s_cmp_ge_u32 s72, 14
    s_cselect_b32 s94, 1, 0
    s_cmp_ge_u32 s68, 4
    s_cbranch_scc1 L_B
    s_lshl_b32 s78, s69, 6
    s_lshl_b32 s73, s70, 1
    s_add_u32 s78, s78, s73
    s_lshr_b32 s79, s68, 1
    s_and_b32 s86, s68, 1
    s_add_u32 s73, s78, s79
    s_lshl_b32 s73, s73, 8
    s_lshl_b32 s74, s86, 7
    s_add_u32 s73, s73, s74
    v_lshlrev_b32 v4, 1, v0
    v_add_u32 v4, s73, v4
    v_lshrrev_b32 v2, 1, v0
    v_lshlrev_b32 v2, 10, v2
    v_and_b32 v3, 1, v0
    v_lshl_add_u32 v2, v3, 4, v2
    s_lshl_b32 s87, s70, 16
    s_lshl_b32 s74, s68, 5
    s_add_u32 s87, s87, s74
    s_lshl_b32 s74, s69, 7
    s_add_u32 s87, s87, s74
    v_lshrrev_b32 v5, 2, v0
    v_lshlrev_b32 v5, 10, v5
    v_lshrrev_b32 v6, 4, v0
    v_xor_b32 v7, v6, v0
    v_and_b32 v7, 3, v7
    v_lshl_add_u32 v200, v7, 4, v5
    v_add_u32 v201, 15360, v200
    v_mul_u32_u24 v5, 3584, v6
    v_lshlrev_b32 v6, 2, v6
    v_xor_b32 v6, v6, v0
    v_and_b32_e64 v6, 15, v6
    v_lshl_add_u32 v6, v6, 4, v5
    v_add_u32 v202, 2048, v6
    v_add_u32 v203, 15360, v6
    s_lshl_b32 s92, s71, 17
    s_lshl_b32 s73, s68, 15
    s_add_u32 s92, s92, s73
    s_lshl_b32 s93, s72, 8
    s_mul_i32 s73, s68, 28672
    s_add_u32 s93, s93, s73
    s_and_b32 s73, s71, 1
    s_lshl_b32 s73, s73, 3
    s_add_u32 s73, s72, s73
    s_and_b32 s73, s73, 15
    s_lshl_b32 s74, s73, 6
    s_add_u32 s89, s92, s74
    s_mul_i32 s74, s73, 114688
    s_add_u32 s90, s93, s74
    s_lshl_b32 s95, s68, 12
    s_cmp_eq_u32 s94, 1
    s_cselect_b32 s92, 0x40000000, s92
    s_cselect_b32 s89, 0x40000000, s89
    s_cselect_b32 s93, 0x40000000, s93
    s_cselect_b32 s90, 0x40000000, s90
    s_add_u32 s91, s92, 1024
    s_lshl_b32 s74, s68, 11
    s_add_u32 m0, s74, 150528
    s_lshl_b32 s73, s78, 1
    s_waitcnt lgkmcnt(0)
    s_nop 0
    global_load_ushort v8, v4, s[10:11]
    global_load_ushort v9, v4, s[12:13]
    global_load_ushort v10, v4, s[14:15]
    global_load_ushort v11, v4, s[16:17]
    global_load_ushort v12, v4, s[18:19]
    global_load_ushort v13, v4, s[20:21]
    s_load_dword s76, s[22:23], s73
    s_load_dword s77, s[24:25], s73
    s_mov_b32 s44, s8
    s_mov_b32 s45, s9
    s_mov_b32 s46, 0x200000
    s_mov_b32 s47, 0x20000
    buffer_load_dwordx4 v2, s[44:47], s87 offen lds
    s_add_u32 s87, s87, 31744
    buffer_load_dwordx4 v2, s[44:47], s87 offen offset:1024 lds
    s_sub_u32 s56, s28, 4096
    s_subb_u32 s57, s29, 0
    s_mov_b32 s58, 0x1c1000
    s_mov_b32 s59, 0x20000
    s_add_u32 m0, s95, 0
    s_nop 0
    s_nop 0
    buffer_load_dwordx4 v200, s[44:47], s89 offen lds
    buffer_load_dwordx4 v201, s[44:47], s89 offen offset:1024 lds
    buffer_load_dwordx4 v202, s[56:59], s90 offen offset:2048 lds
    buffer_load_dwordx4 v203, s[56:59], s90 offen offset:3072 lds
    s_add_u32 s89, s89, 64
    s_add_u32 s90, s90, 114688
    s_cmp_eq_u32 s89, s91
    s_cselect_b32 s89, s92, s89
    s_cselect_b32 s90, s93, s90
    s_add_u32 m0, s95, 16384
    s_nop 0
    s_nop 0
    buffer_load_dwordx4 v200, s[44:47], s89 offen lds
    buffer_load_dwordx4 v201, s[44:47], s89 offen offset:1024 lds
    buffer_load_dwordx4 v202, s[56:59], s90 offen offset:2048 lds
    buffer_load_dwordx4 v203, s[56:59], s90 offen offset:3072 lds
    s_add_u32 s89, s89, 64
    s_add_u32 s90, s90, 114688
    s_cmp_eq_u32 s89, s91
    s_cselect_b32 s89, s92, s89
    s_cselect_b32 s90, s93, s90
    s_mov_b32 s48, s42
    s_mov_b32 s49, s43
    s_mov_b32 s50, 0x2000000
    s_mov_b32 s51, 0x20000
    s_mov_b32 s52, s40
    s_mov_b32 s53, s41
    s_mov_b32 s54, 0x100
    s_mov_b32 s55, 0x20000
    s_mov_b32 s60, s32
    s_mov_b32 s61, s33
    s_mov_b32 s62, 0x1c0000
    s_mov_b32 s63, 0x20000
    s_cmp_ge_u32 s2, 8
    s_cbranch_scc1 Lnp_1
    s_cmp_lg_u32 s68, 0
    s_cbranch_scc1 Lnp_1
    s_memrealtime s[100:101]
    s_waitcnt lgkmcnt(0)
    s_or_b32 s100, s100, 1
    v_mov_b32 v20, s100
    v_mov_b32 v21, 0
    v_mov_b32 v22, 0
    s_mov_b64 exec, 1
    buffer_atomic_cmpswap v[20:21], v22, s[52:55], 0 offen sc1
    s_mov_b64 exec, -1
Lnp_1:
    s_lshl_b32 s81, s69, 12
    s_lshl_b32 s73, s70, 7
    s_add_u32 s82, s81, s73
    s_add_u32 s80, s82, 0xc00000
    s_add_u32 s82, s82, 0xc08000
    s_add_u32 s81, s81, 0xc00000
    s_lshl_b32 s85, s71, 11
    s_add_u32 s85, s85, 0xc10000
    s_lshl_b32 s73, s72, 7
    s_add_u32 s84, s85, s73
    s_and_b32 s73, s70, 7
    s_lshl_b32 s83, s73, 12
    s_add_u32 s83, s83, 0xc08000
    s_cmp_lg_u32 s68, 0
    s_cbranch_scc1 Lini_2
    v_lshlrev_b32 v6, 2, v0
    v_add_u32 v6, 159744, v6
    v_mov_b32 v7, 0
    s_mov_b32 exec_hi, 0
    ds_write_b32 v6, v7
    s_mov_b64 exec, -1
Lini_2:
    v_lshrrev_b32 v5, 4, v0
    v_lshlrev_b32 v5, 3, v5
    v_lshrrev_b32 v6, 2, v0
    v_and_b32 v6, 3, v6
    v_add_u32 v5, v5, v6
    v_lshlrev_b32 v5, 5, v5
    v_and_b32 v6, 3, v0
    v_lshl_add_u32 v5, v6, 3, v5
    s_lshl_b32 s73, s68, 11
    s_add_u32 s73, s73, 150528
    v_add_u32 v204, s73, v5
    v_and_b32 v6, 15, v0
    v_lshrrev_b32 v7, 4, v0
    v_and_b32 v5, 7, v6
    v_xor_b32 v7, v7, v5
    v_lshlrev_b32_e64 v7, 4, v7
    v_lshl_add_u32 v7, v6, 7, v7
    v_add_u32 v205, s73, v7
    v_lshlrev_b32 v5, 4, v0
    v_add_u32 v206, s73, v5
    v_lshrrev_b32 v5, 3, v0
    v_and_b32 v6, 7, v0
    v_xor_b32 v6, v5, v6
    v_lshlrev_b32_e64 v5, 12, v5
    v_lshl_add_u32 v207, v6, 4, v5
    s_lshl_b32 s73, s69, 18
    s_lshl_b32 s74, s68, 16
    s_add_u32 s73, s73, s74
    s_lshl_b32 s74, s70, 7
    s_add_u32 s97, s73, s74
    s_waitcnt vmcnt(8)
    ds_read_b64_tr_b16 v[16:17], v204 offset:0
    ds_read_b64_tr_b16 v[18:19], v204 offset:128
    ds_read_b64_tr_b16 v[20:21], v204 offset:1024
    ds_read_b64_tr_b16 v[22:23], v204 offset:1152
    v_xor_b32 v5, 64, v205
    s_waitcnt lgkmcnt(0)
    ds_write_b128 v205, v[16:19]
    ds_write_b128 v5, v[20:23]
    s_waitcnt lgkmcnt(0)
    ds_read_b128 v[16:19], v206
    ds_read_b128 v[20:23], v206 offset:1024
    s_waitcnt lgkmcnt(1)
    buffer_store_dwordx4 v[16:19], v207, s[48:51], s97 offen sc1
    s_add_u32 s97, s97, 32768
    s_waitcnt lgkmcnt(0)
    buffer_store_dwordx4 v[20:23], v207, s[48:51], s97 offen sc1
    s_cmp_lg_u32 s68, 0
    s_cbranch_scc1 Lnl_3
    v_mov_b32 v253, 0
    buffer_load_dword v252, v253, s[52:55], 0 offen sc1
Lnl_3:
    s_mul_i32 s88, s79, 34272
    s_add_u32 s88, s88, 81920
    s_mov_b32 s98, s88
    v_and_b32 v16, 15, v0
    v_sub_u32 v16, 15, v16
    v_lshrrev_b32 v17, 1, v16
    v_and_b32 v17, 1, v17
    v_add_u32 v17, v17, v16
    v_lshrrev_b32 v17, 1, v17
    v_lshrrev_b32 v18, 2, v16
    v_and_b32_e64 v18, 1, v18
    v_add3_u32 v18, v18, v16, 1
    v_lshrrev_b32 v18, 2, v18
    v_lshrrev_b32 v19, 3, v16
    v_and_b32_e64 v19, 1, v19
    v_add3_u32 v19, v19, v16, 3
    v_lshrrev_b32 v19, 3, v19
    v_add_u32 v208, 16, v16
    v_add_u32 v209, 32, v17
    v_add_u32 v210, 41, v18
    v_add_u32 v211, 46, v18
    s_cmp_eq_u32 s86, 0
    s_cbranch_scc1 Lp0_4
    v_add_u32 v208, 51, v19
    v_add_u32 v209, 54, v19
    v_add_u32 v210, 57, v19
    v_add_u32 v211, 60, v19
Lp0_4:
    v_lshrrev_b32 v16, 4, v0
    v_lshlrev_b32 v17, 4, v16
    v_add_u32 v17, s88, v17
    v_mul_u32_u24 v208, 544, v208
    v_add_u32_e64 v208, v208, v17
    v_mul_u32_u24 v209, 544, v209
    v_add_u32_e64 v209, v209, v17
    v_mul_u32_u24 v210, 544, v210
    v_add_u32_e64 v210, v210, v17
    v_mul_u32_u24 v211, 544, v211
    v_add_u32 v211, v211, v17
    v_and_b32 v18, 15, v0
    v_mul_u32_u24 v212, 544, v18
    v_add_u32 v212, v212, v17
    v_lshlrev_b32 v18, 5, v18
    v_lshlrev_b32 v16, 3, v16
    v_sub_u32 v16, v16, v18
    s_lshl_b32 s73, s86, 11
    s_sub_u32 s74, s98, s73
    s_add_u32 s74, s74, 2528
    v_add_u32 v213, s74, v16
    v_lshrrev_b32 v16, 2, v0
    v_mul_u32_u24 v16, 4160, v16
    v_and_b32_e64 v17, 3, v0
    v_lshl_add_u32 v16, v17, 4, v16
    s_add_u32 s74, s98, 4096
    v_add_u32 v214, s74, v16
    s_add_u32 s73, s73, s98
    v_lshlrev_b32 v16, 4, v0
    v_add_u32 v215, s73, v16
    s_lshl_b32 s73, s86, 8
    s_add_u32 s73, s73, s88
    v_lshlrev_b32 v5, 2, v0
    v_add_u32 v5, s73, v5
    s_waitcnt vmcnt(12) lgkmcnt(0)
    v_lshlrev_b32 v8, 16, v8
    v_lshlrev_b32 v9, 16, v9
    v_lshlrev_b32 v10, 16, v10
    v_lshlrev_b32 v11, 16, v11
    v_lshlrev_b32 v12, 16, v12
    v_lshlrev_b32 v13, 16, v13
    s_lshl_b32 s73, s79, 4
    s_lshr_b32 s76, s76, s73
    s_lshl_b32 s76, s76, 16
    s_lshr_b32 s77, s77, s73
    s_lshl_b32 s77, s77, 16
    v_mov_b32_e64 v16, s76
    s_mov_b32 s73, 0x3fb8aa3b
    s_mov_b32 s74, 0x32a5705f
    s_mov_b32 s75, 0x3f317218
    v_mul_f32_e64 v17, s73, v16
    v_fma_f32 v18, v16, s73, -v17
    v_fma_f32 v18, v16, s74, v18
    v_exp_f32 v17, v17
    v_mul_f32 v18, s75, v18
    v_fma_f32 v17, v17, v18, v17
    v_cvt_pk_bf16_f32 v17, v17, v17
    v_and_b32 v17, 0xffff0000, v17
    v_mul_f32 v18, v17, v8
    v_mul_f32 v19, v17, v9
    v_mul_f32 v10, v17, v10
    v_mul_f32 v11, v17, v11
    v_mul_f32 v18, s73, v18
    s_mov_b32 s74, 0x3e22f983
    v_mul_f32 v19, s74, v19
    v_mul_f32 v26, 0x3f800000, v18
    v_mul_f32_e64 v27, 0x3f800000, v19
    v_mul_f32 v28, 0x41800000, v18
    v_mul_f32 v29, 0x41800000, v19
    v_mul_f32 v30, 0x43800000, v18
    v_mul_f32 v31, 0x43800000, v19
    v_fract_f32 v27, v27
    v_fract_f32 v29, v29
    v_fract_f32 v31, v31
    v_exp_f32 v26, v26
    v_cos_f32 v20, v27
    v_sin_f32 v21, v27
    v_exp_f32 v28, v28
    v_cos_f32 v22, v29
    v_sin_f32 v23, v29
    v_exp_f32 v30, v30
    v_cos_f32 v24, v31
    v_sin_f32 v25, v31
    v_mul_f32 v20, v26, v20
    v_mul_f32 v21, v26, v21
    v_mul_f32_e64 v22, v28, v22
    s_add_u32 m0, s95, 32768
    s_nop 0
    s_nop 0
    buffer_load_dwordx4 v200, s[44:47], s89 offen lds
    buffer_load_dwordx4 v201, s[44:47], s89 offen offset:1024 lds
    buffer_load_dwordx4 v202, s[56:59], s90 offen offset:2048 lds
    buffer_load_dwordx4 v203, s[56:59], s90 offen offset:3072 lds
    s_add_u32 s89, s89, 64
    s_add_u32 s90, s90, 114688
    s_cmp_eq_u32 s89, s91
    s_cselect_b32 s89, s92, s89
    s_cselect_b32 s90, s93, s90
    v_mul_f32 v23, v28, v23
    v_mul_f32 v24, v30, v24
    v_mul_f32_e64 v25, v30, v25
    v_pk_mul_f32 v[32:33], v[12:13], v[10:11] op_sel:[0,0] op_sel_hi:[0,1]
    v_pk_fma_f32 v[32:33], v[12:13], v[10:11], v[32:33] op_sel:[1,1,0] op_sel_hi:[1,0,1] neg_lo:[0,1,0]
    v_mov_b32 v36, 1.0
    v_mov_b32 v37, 0
    v_pk_mul_f32 v[40:41], v[20:21], v[20:21] op_sel:[0,0] op_sel_hi:[0,1]
    v_pk_fma_f32 v[40:41], v[20:21], v[20:21], v[40:41] op_sel:[1,1,0] op_sel_hi:[1,0,1] neg_lo:[0,1,0]
    v_pk_mul_f32 v[46:47], v[24:25], v[24:25] op_sel:[0,0] op_sel_hi:[0,1]
    v_pk_fma_f32 v[46:47], v[24:25], v[24:25], v[46:47] op_sel:[1,1,0] op_sel_hi:[1,0,1] neg_lo:[0,1,0]
    v_pk_mul_f32 v[42:43], v[40:41], v[40:41] op_sel:[0,0] op_sel_hi:[0,1]
    v_pk_fma_f32 v[42:43], v[40:41], v[40:41], v[42:43] op_sel:[1,1,0] op_sel_hi:[1,0,1] neg_lo:[0,1,0]
    v_pk_mul_f32 v[48:49], v[46:47], v[24:25] op_sel:[0,0] op_sel_hi:[0,1]
    v_pk_fma_f32 v[48:49], v[46:47], v[24:25], v[48:49] op_sel:[1,1,0] op_sel_hi:[1,0,1] neg_lo:[0,1,0]
    v_pk_mul_f32 v[50:51], v[46:47], v[46:47] op_sel:[0,0] op_sel_hi:[0,1]
    v_pk_fma_f32 v[50:51], v[46:47], v[46:47], v[50:51] op_sel:[1,1,0] op_sel_hi:[1,0,1] neg_lo:[0,1,0]
    v_pk_mul_f32 v[44:45], v[42:43], v[42:43] op_sel:[0,0] op_sel_hi:[0,1]
    v_pk_fma_f32 v[44:45], v[42:43], v[42:43], v[44:45] op_sel:[1,1,0] op_sel_hi:[1,0,1] neg_lo:[0,1,0]
    v_pk_mul_f32 v[52:53], v[50:51], v[24:25] op_sel:[0,0] op_sel_hi:[0,1]
    v_pk_fma_f32 v[52:53], v[50:51], v[24:25], v[52:53] op_sel:[1,1,0] op_sel_hi:[1,0,1] neg_lo:[0,1,0]
    v_pk_mul_f32 v[34:35], v[32:33], v[22:23] op_sel:[0,0] op_sel_hi:[0,1]
    v_pk_fma_f32 v[34:35], v[32:33], v[22:23], v[34:35] op_sel:[1,1,0] op_sel_hi:[1,0,1] neg_lo:[0,1,0]
    v_pk_mul_f32 v[38:39], v[36:37], v[20:21] op_sel:[0,0] op_sel_hi:[0,1]
    v_pk_fma_f32 v[38:39], v[36:37], v[20:21], v[38:39] op_sel:[1,1,0] op_sel_hi:[1,0,1] neg_lo:[0,1,0]
    v_cvt_pk_bf16_f32 v6, v32, -v33
    ds_write_b32 v5, v6 offset:0
    v_cvt_pk_bf16_f32 v7, v36, v37
    ds_write_b32 v5, v7 offset:8704
    v_cvt_pk_bf16_f32 v6, v24, v25
    ds_write_b32 v5, v6 offset:17408
    v_cvt_pk_bf16_f32 v7, v46, v47
    ds_write_b32 v5, v7 offset:22304
    v_cvt_pk_bf16_f32 v6, v48, v49
    ds_write_b32 v5, v6 offset:25024
    v_pk_mul_f32 v[54:55], v[52:53], v[24:25] op_sel:[0,0] op_sel_hi:[0,1]
    v_pk_fma_f32 v[54:55], v[52:53], v[24:25], v[54:55] op_sel:[1,1,0] op_sel_hi:[1,0,1] neg_lo:[0,1,0]
    v_pk_mul_f32 v[32:33], v[34:35], v[22:23] op_sel:[0,0] op_sel_hi:[0,1]
    v_pk_fma_f32 v[32:33], v[34:35], v[22:23], v[32:33] op_sel:[1,1,0] op_sel_hi:[1,0,1] neg_lo:[0,1,0]
    v_pk_mul_f32 v[36:37], v[38:39], v[20:21] op_sel:[0,0] op_sel_hi:[0,1]
    v_pk_fma_f32 v[36:37], v[38:39], v[20:21], v[36:37] op_sel:[1,1,0] op_sel_hi:[1,0,1] neg_lo:[0,1,0]
    v_cvt_pk_bf16_f32 v7, v34, -v35
    ds_write_b32 v5, v7 offset:544
    v_cvt_pk_bf16_f32 v6, v38, v39
    ds_write_b32 v5, v6 offset:9248
    v_pk_mul_f32 v[60:61], v[24:25], v[40:41] op_sel:[0,0] op_sel_hi:[0,1]
    v_pk_fma_f32 v[60:61], v[24:25], v[40:41], v[60:61] op_sel:[1,1,0] op_sel_hi:[1,0,1] neg_lo:[0,1,0]
    v_cvt_pk_bf16_f32 v7, v60, v61
    ds_write_b32 v5, v7 offset:17952
    v_pk_mul_f32 v[64:65], v[46:47], v[42:43] op_sel:[0,0] op_sel_hi:[0,1]
    v_pk_fma_f32 v[64:65], v[46:47], v[42:43], v[64:65] op_sel:[1,1,0] op_sel_hi:[1,0,1] neg_lo:[0,1,0]
    v_pk_mul_f32 v[68:69], v[48:49], v[42:43] op_sel:[0,0] op_sel_hi:[0,1]
    v_pk_fma_f32 v[68:69], v[48:49], v[42:43], v[68:69] op_sel:[1,1,0] op_sel_hi:[1,0,1] neg_lo:[0,1,0]
    v_cvt_pk_bf16_f32 v6, v64, v65
    ds_write_b32 v5, v6 offset:22848
    v_cvt_pk_bf16_f32 v7, v68, v69
    ds_write_b32 v5, v7 offset:25568
    v_pk_mul_f32 v[34:35], v[32:33], v[22:23] op_sel:[0,0] op_sel_hi:[0,1]
    v_pk_fma_f32 v[34:35], v[32:33], v[22:23], v[34:35] op_sel:[1,1,0] op_sel_hi:[1,0,1] neg_lo:[0,1,0]
    v_pk_mul_f32 v[38:39], v[36:37], v[20:21] op_sel:[0,0] op_sel_hi:[0,1]
    v_pk_fma_f32 v[38:39], v[36:37], v[20:21], v[38:39] op_sel:[1,1,0] op_sel_hi:[1,0,1] neg_lo:[0,1,0]
    v_cvt_pk_bf16_f32 v6, v32, -v33
    ds_write_b32 v5, v6 offset:1088
    v_cvt_pk_bf16_f32 v7, v36, v37
    ds_write_b32 v5, v7 offset:9792
    v_pk_mul_f32 v[58:59], v[60:61], v[40:41] op_sel:[0,0] op_sel_hi:[0,1]
    v_pk_fma_f32 v[58:59], v[60:61], v[40:41], v[58:59] op_sel:[1,1,0] op_sel_hi:[1,0,1] neg_lo:[0,1,0]
    v_cvt_pk_bf16_f32 v6, v58, v59
    ds_write_b32 v5, v6 offset:18496
    v_pk_mul_f32 v[62:63], v[64:65], v[42:43] op_sel:[0,0] op_sel_hi:[0,1]
    v_pk_fma_f32 v[62:63], v[64:65], v[42:43], v[62:63] op_sel:[1,1,0] op_sel_hi:[1,0,1] neg_lo:[0,1,0]
    v_pk_mul_f32 v[66:67], v[68:69], v[42:43] op_sel:[0,0] op_sel_hi:[0,1]
    v_pk_fma_f32 v[66:67], v[68:69], v[42:43], v[66:67] op_sel:[1,1,0] op_sel_hi:[1,0,1] neg_lo:[0,1,0]
    v_cvt_pk_bf16_f32 v7, v62, v63
    ds_write_b32 v5, v7 offset:23392
    v_cvt_pk_bf16_f32 v6, v66, v67
    ds_write_b32 v5, v6 offset:26112
    v_pk_mul_f32 v[32:33], v[34:35], v[22:23] op_sel:[0,0] op_sel_hi:[0,1]
    v_pk_fma_f32 v[32:33], v[34:35], v[22:23], v[32:33] op_sel:[1,1,0] op_sel_hi:[1,0,1] neg_lo:[0,1,0]
    v_pk_mul_f32 v[36:37], v[38:39], v[20:21] op_sel:[0,0] op_sel_hi:[0,1]
    v_pk_fma_f32 v[36:37], v[38:39], v[20:21], v[36:37] op_sel:[1,1,0] op_sel_hi:[1,0,1] neg_lo:[0,1,0]
    v_cvt_pk_bf16_f32 v7, v34, -v35
    ds_write_b32 v5, v7 offset:1632
    v_cvt_pk_bf16_f32 v6, v38, v39
    ds_write_b32 v5, v6 offset:10336
    v_pk_mul_f32 v[60:61], v[58:59], v[40:41] op_sel:[0,0] op_sel_hi:[0,1]
    v_pk_fma_f32 v[60:61], v[58:59], v[40:41], v[60:61] op_sel:[1,1,0] op_sel_hi:[1,0,1] neg_lo:[0,1,0]
    v_cvt_pk_bf16_f32 v7, v60, v61
    ds_write_b32 v5, v7 offset:19040
    v_pk_mul_f32 v[64:65], v[62:63], v[42:43] op_sel:[0,0] op_sel_hi:[0,1]
    v_pk_fma_f32 v[64:65], v[62:63], v[42:43], v[64:65] op_sel:[1,1,0] op_sel_hi:[1,0,1] neg_lo:[0,1,0]
    v_pk_mul_f32 v[68:69], v[66:67], v[42:43] op_sel:[0,0] op_sel_hi:[0,1]
    v_pk_fma_f32 v[68:69], v[66:67], v[42:43], v[68:69] op_sel:[1,1,0] op_sel_hi:[1,0,1] neg_lo:[0,1,0]
    v_cvt_pk_bf16_f32 v6, v64, v65
    ds_write_b32 v5, v6 offset:23936
    v_cvt_pk_bf16_f32 v7, v68, v69
    ds_write_b32 v5, v7 offset:26656
    v_pk_mul_f32 v[34:35], v[32:33], v[22:23] op_sel:[0,0] op_sel_hi:[0,1]
    v_pk_fma_f32 v[34:35], v[32:33], v[22:23], v[34:35] op_sel:[1,1,0] op_sel_hi:[1,0,1] neg_lo:[0,1,0]
    v_pk_mul_f32 v[38:39], v[36:37], v[20:21] op_sel:[0,0] op_sel_hi:[0,1]
    v_pk_fma_f32 v[38:39], v[36:37], v[20:21], v[38:39] op_sel:[1,1,0] op_sel_hi:[1,0,1] neg_lo:[0,1,0]
    v_cvt_pk_bf16_f32 v6, v32, -v33
    ds_write_b32 v5, v6 offset:2176
    v_cvt_pk_bf16_f32 v7, v36, v37
    s_add_u32 m0, s95, 49152
    s_nop 0
    s_nop 0
    buffer_load_dwordx4 v200, s[44:47], s89 offen lds
    buffer_load_dwordx4 v201, s[44:47], s89 offen offset:1024 lds
    buffer_load_dwordx4 v202, s[56:59], s90 offen offset:2048 lds
    buffer_load_dwordx4 v203, s[56:59], s90 offen offset:3072 lds
    s_add_u32 s89, s89, 64
    s_add_u32 s90, s90, 114688
    s_cmp_eq_u32 s89, s91
    s_cselect_b32 s89, s92, s89
    s_cselect_b32 s90, s93, s90
    ds_write_b32 v5, v7 offset:10880
    v_pk_mul_f32 v[58:59], v[60:61], v[40:41] op_sel:[0,0] op_sel_hi:[0,1]
    v_pk_fma_f32 v[58:59], v[60:61], v[40:41], v[58:59] op_sel:[1,1,0] op_sel_hi:[1,0,1] neg_lo:[0,1,0]
    v_cvt_pk_bf16_f32 v6, v58, v59
    ds_write_b32 v5, v6 offset:19584
    v_pk_mul_f32 v[62:63], v[64:65], v[42:43] op_sel:[0,0] op_sel_hi:[0,1]
    v_pk_fma_f32 v[62:63], v[64:65], v[42:43], v[62:63] op_sel:[1,1,0] op_sel_hi:[1,0,1] neg_lo:[0,1,0]
    v_pk_mul_f32 v[66:67], v[68:69], v[42:43] op_sel:[0,0] op_sel_hi:[0,1]
    v_pk_fma_f32 v[66:67], v[68:69], v[42:43], v[66:67] op_sel:[1,1,0] op_sel_hi:[1,0,1] neg_lo:[0,1,0]
    v_cvt_pk_bf16_f32 v7, v62, v63
    ds_write_b32 v5, v7 offset:24480
    v_cvt_pk_bf16_f32 v6, v66, v67
    ds_write_b32 v5, v6 offset:27200
    v_pk_mul_f32 v[32:33], v[34:35], v[22:23] op_sel:[0,0] op_sel_hi:[0,1]
    v_pk_fma_f32 v[32:33], v[34:35], v[22:23], v[32:33] op_sel:[1,1,0] op_sel_hi:[1,0,1] neg_lo:[0,1,0]
    v_pk_mul_f32 v[36:37], v[38:39], v[20:21] op_sel:[0,0] op_sel_hi:[0,1]
    v_pk_fma_f32 v[36:37], v[38:39], v[20:21], v[36:37] op_sel:[1,1,0] op_sel_hi:[1,0,1] neg_lo:[0,1,0]
    v_cvt_pk_bf16_f32 v7, v34, -v35
    ds_write_b32 v5, v7 offset:2720
    v_cvt_pk_bf16_f32 v6, v38, v39
    ds_write_b32 v5, v6 offset:11424
    v_pk_mul_f32 v[60:61], v[58:59], v[40:41] op_sel:[0,0] op_sel_hi:[0,1]
    v_pk_fma_f32 v[60:61], v[58:59], v[40:41], v[60:61] op_sel:[1,1,0] op_sel_hi:[1,0,1] neg_lo:[0,1,0]
    v_cvt_pk_bf16_f32 v7, v60, v61
    ds_write_b32 v5, v7 offset:20128
    v_pk_mul_f32 v[56:57], v[54:55], v[24:25] op_sel:[0,0] op_sel_hi:[0,1]
    v_pk_fma_f32 v[56:57], v[54:55], v[24:25], v[56:57] op_sel:[1,1,0] op_sel_hi:[1,0,1] neg_lo:[0,1,0]
    v_pk_mul_f32 v[34:35], v[32:33], v[22:23] op_sel:[0,0] op_sel_hi:[0,1]
    v_pk_fma_f32 v[34:35], v[32:33], v[22:23], v[34:35] op_sel:[1,1,0] op_sel_hi:[1,0,1] neg_lo:[0,1,0]
    v_pk_mul_f32 v[38:39], v[36:37], v[20:21] op_sel:[0,0] op_sel_hi:[0,1]
    v_pk_fma_f32 v[38:39], v[36:37], v[20:21], v[38:39] op_sel:[1,1,0] op_sel_hi:[1,0,1] neg_lo:[0,1,0]
    v_cvt_pk_bf16_f32 v6, v32, -v33
    ds_write_b32 v5, v6 offset:3264
    v_cvt_pk_bf16_f32 v7, v36, v37
    ds_write_b32 v5, v7 offset:11968
    v_pk_mul_f32 v[58:59], v[60:61], v[40:41] op_sel:[0,0] op_sel_hi:[0,1]
    v_pk_fma_f32 v[58:59], v[60:61], v[40:41], v[58:59] op_sel:[1,1,0] op_sel_hi:[1,0,1] neg_lo:[0,1,0]
    v_cvt_pk_bf16_f32 v6, v58, v59
    ds_write_b32 v5, v6 offset:20672
    v_pk_mul_f32 v[32:33], v[34:35], v[22:23] op_sel:[0,0] op_sel_hi:[0,1]
    v_pk_fma_f32 v[32:33], v[34:35], v[22:23], v[32:33] op_sel:[1,1,0] op_sel_hi:[1,0,1] neg_lo:[0,1,0]
    v_pk_mul_f32 v[36:37], v[38:39], v[20:21] op_sel:[0,0] op_sel_hi:[0,1]
    v_pk_fma_f32 v[36:37], v[38:39], v[20:21], v[36:37] op_sel:[1,1,0] op_sel_hi:[1,0,1] neg_lo:[0,1,0]
    v_cvt_pk_bf16_f32 v7, v34, -v35
    ds_write_b32 v5, v7 offset:3808
    v_cvt_pk_bf16_f32 v6, v38, v39
    ds_write_b32 v5, v6 offset:12512
    v_pk_mul_f32 v[60:61], v[58:59], v[40:41] op_sel:[0,0] op_sel_hi:[0,1]
    v_pk_fma_f32 v[60:61], v[58:59], v[40:41], v[60:61] op_sel:[1,1,0] op_sel_hi:[1,0,1] neg_lo:[0,1,0]
    v_cvt_pk_bf16_f32 v7, v60, v61
    ds_write_b32 v5, v7 offset:21216
    v_pk_mul_f32 v[34:35], v[32:33], v[22:23] op_sel:[0,0] op_sel_hi:[0,1]
    v_pk_fma_f32 v[34:35], v[32:33], v[22:23], v[34:35] op_sel:[1,1,0] op_sel_hi:[1,0,1] neg_lo:[0,1,0]
    v_pk_mul_f32 v[38:39], v[36:37], v[20:21] op_sel:[0,0] op_sel_hi:[0,1]
    v_pk_fma_f32 v[38:39], v[36:37], v[20:21], v[38:39] op_sel:[1,1,0] op_sel_hi:[1,0,1] neg_lo:[0,1,0]
    v_cvt_pk_bf16_f32 v6, v32, -v33
    ds_write_b32 v5, v6 offset:4352
    v_cvt_pk_bf16_f32 v7, v36, v37
    ds_write_b32 v5, v7 offset:13056
    v_pk_mul_f32 v[58:59], v[60:61], v[40:41] op_sel:[0,0] op_sel_hi:[0,1]
    v_pk_fma_f32 v[58:59], v[60:61], v[40:41], v[58:59] op_sel:[1,1,0] op_sel_hi:[1,0,1] neg_lo:[0,1,0]
    v_cvt_pk_bf16_f32 v6, v58, v59
    ds_write_b32 v5, v6 offset:21760
    v_pk_mul_f32 v[32:33], v[34:35], v[22:23] op_sel:[0,0] op_sel_hi:[0,1]
    v_pk_fma_f32 v[32:33], v[34:35], v[22:23], v[32:33] op_sel:[1,1,0] op_sel_hi:[1,0,1] neg_lo:[0,1,0]
    v_pk_mul_f32 v[36:37], v[38:39], v[20:21] op_sel:[0,0] op_sel_hi:[0,1]
    v_pk_fma_f32 v[36:37], v[38:39], v[20:21], v[36:37] op_sel:[1,1,0] op_sel_hi:[1,0,1] neg_lo:[0,1,0]
    v_cvt_pk_bf16_f32 v7, v34, -v35
    ds_write_b32 v5, v7 offset:4896
    v_cvt_pk_bf16_f32 v6, v38, v39
    ds_write_b32 v5, v6 offset:13600
    v_pk_mul_f32 v[70:71], v[50:51], v[44:45] op_sel:[0,0] op_sel_hi:[0,1]
    v_pk_fma_f32 v[70:71], v[50:51], v[44:45], v[70:71] op_sel:[1,1,0] op_sel_hi:[1,0,1] neg_lo:[0,1,0]
    v_pk_mul_f32 v[72:73], v[50:51], v[22:23] op_sel:[0,0] op_sel_hi:[0,1]
    v_pk_fma_f32 v[72:73], v[50:51], v[22:23], v[72:73] op_sel:[1,1,0] op_sel_hi:[1,0,1] neg_lo:[0,1,0]
    v_cvt_pk_bf16_f32 v7, v50, v51
    ds_write_b32 v5, v7 offset:27744
    s_add_u32 m0, s95, 65536
    s_nop 0
    s_nop 0
    buffer_load_dwordx4 v200, s[44:47], s89 offen lds
    buffer_load_dwordx4 v201, s[44:47], s89 offen offset:1024 lds
    buffer_load_dwordx4 v202, s[56:59], s90 offen offset:2048 lds
    buffer_load_dwordx4 v203, s[56:59], s90 offen offset:3072 lds
    s_add_u32 s89, s89, 64
    s_add_u32 s90, s90, 114688
    s_cmp_eq_u32 s89, s91
    s_cselect_b32 s89, s92, s89
    s_cselect_b32 s90, s93, s90
    v_cvt_pk_bf16_f32 v6, v70, v71
    ds_write_b32 v5, v6 offset:28288
    v_cvt_pk_bf16_f32 v7, v72, v73
    ds_write_b32 v5, v7 offset:28832
    v_pk_mul_f32 v[34:35], v[32:33], v[22:23] op_sel:[0,0] op_sel_hi:[0,1]
    v_pk_fma_f32 v[34:35], v[32:33], v[22:23], v[34:35] op_sel:[1,1,0] op_sel_hi:[1,0,1] neg_lo:[0,1,0]
    v_pk_mul_f32 v[38:39], v[36:37], v[20:21] op_sel:[0,0] op_sel_hi:[0,1]
    v_pk_fma_f32 v[38:39], v[36:37], v[20:21], v[38:39] op_sel:[1,1,0] op_sel_hi:[1,0,1] neg_lo:[0,1,0]
    v_cvt_pk_bf16_f32 v6, v32, -v33
    ds_write_b32 v5, v6 offset:5440
    v_cvt_pk_bf16_f32 v7, v36, v37
    ds_write_b32 v5, v7 offset:14144
    v_pk_mul_f32 v[74:75], v[52:53], v[44:45] op_sel:[0,0] op_sel_hi:[0,1]
    v_pk_fma_f32 v[74:75], v[52:53], v[44:45], v[74:75] op_sel:[1,1,0] op_sel_hi:[1,0,1] neg_lo:[0,1,0]
    v_pk_mul_f32 v[76:77], v[52:53], v[22:23] op_sel:[0,0] op_sel_hi:[0,1]
    v_pk_fma_f32 v[76:77], v[52:53], v[22:23], v[76:77] op_sel:[1,1,0] op_sel_hi:[1,0,1] neg_lo:[0,1,0]
    v_cvt_pk_bf16_f32 v6, v52, v53
    ds_write_b32 v5, v6 offset:29376
    v_cvt_pk_bf16_f32 v7, v74, v75
    ds_write_b32 v5, v7 offset:29920
    v_cvt_pk_bf16_f32 v6, v76, v77
    ds_write_b32 v5, v6 offset:30464
    v_pk_mul_f32 v[32:33], v[34:35], v[22:23] op_sel:[0,0] op_sel_hi:[0,1]
    v_pk_fma_f32 v[32:33], v[34:35], v[22:23], v[32:33] op_sel:[1,1,0] op_sel_hi:[1,0,1] neg_lo:[0,1,0]
    v_pk_mul_f32 v[36:37], v[38:39], v[20:21] op_sel:[0,0] op_sel_hi:[0,1]
    v_pk_fma_f32 v[36:37], v[38:39], v[20:21], v[36:37] op_sel:[1,1,0] op_sel_hi:[1,0,1] neg_lo:[0,1,0]
    v_cvt_pk_bf16_f32 v7, v34, -v35
    ds_write_b32 v5, v7 offset:5984
    v_cvt_pk_bf16_f32 v6, v38, v39
    ds_write_b32 v5, v6 offset:14688
    v_pk_mul_f32 v[70:71], v[54:55], v[44:45] op_sel:[0,0] op_sel_hi:[0,1]
    v_pk_fma_f32 v[70:71], v[54:55], v[44:45], v[70:71] op_sel:[1,1,0] op_sel_hi:[1,0,1] neg_lo:[0,1,0]
    v_pk_mul_f32 v[72:73], v[54:55], v[22:23] op_sel:[0,0] op_sel_hi:[0,1]
    v_pk_fma_f32 v[72:73], v[54:55], v[22:23], v[72:73] op_sel:[1,1,0] op_sel_hi:[1,0,1] neg_lo:[0,1,0]
    v_cvt_pk_bf16_f32 v7, v54, v55
    ds_write_b32 v5, v7 offset:31008
    v_cvt_pk_bf16_f32 v6, v70, v71
    ds_write_b32 v5, v6 offset:31552
    v_cvt_pk_bf16_f32 v7, v72, v73
    ds_write_b32 v5, v7 offset:32096
    v_pk_mul_f32 v[34:35], v[32:33], v[22:23] op_sel:[0,0] op_sel_hi:[0,1]
    v_pk_fma_f32 v[34:35], v[32:33], v[22:23], v[34:35] op_sel:[1,1,0] op_sel_hi:[1,0,1] neg_lo:[0,1,0]
    v_pk_mul_f32 v[38:39], v[36:37], v[20:21] op_sel:[0,0] op_sel_hi:[0,1]
    v_pk_fma_f32 v[38:39], v[36:37], v[20:21], v[38:39] op_sel:[1,1,0] op_sel_hi:[1,0,1] neg_lo:[0,1,0]
    v_cvt_pk_bf16_f32 v6, v32, -v33
    ds_write_b32 v5, v6 offset:6528
    v_cvt_pk_bf16_f32 v7, v36, v37
    ds_write_b32 v5, v7 offset:15232
    v_pk_mul_f32 v[74:75], v[56:57], v[44:45] op_sel:[0,0] op_sel_hi:[0,1]
    v_pk_fma_f32 v[74:75], v[56:57], v[44:45], v[74:75] op_sel:[1,1,0] op_sel_hi:[1,0,1] neg_lo:[0,1,0]
    v_pk_mul_f32 v[76:77], v[56:57], v[22:23] op_sel:[0,0] op_sel_hi:[0,1]
    v_pk_fma_f32 v[76:77], v[56:57], v[22:23], v[76:77] op_sel:[1,1,0] op_sel_hi:[1,0,1] neg_lo:[0,1,0]
    v_cvt_pk_bf16_f32 v6, v56, v57
    ds_write_b32 v5, v6 offset:32640
    v_cvt_pk_bf16_f32 v7, v74, v75
    ds_write_b32 v5, v7 offset:33184
    v_cvt_pk_bf16_f32 v6, v76, v77
    ds_write_b32 v5, v6 offset:33728
    v_pk_mul_f32 v[32:33], v[34:35], v[22:23] op_sel:[0,0] op_sel_hi:[0,1]
    v_pk_fma_f32 v[32:33], v[34:35], v[22:23], v[32:33] op_sel:[1,1,0] op_sel_hi:[1,0,1] neg_lo:[0,1,0]
    v_pk_mul_f32 v[36:37], v[38:39], v[20:21] op_sel:[0,0] op_sel_hi:[0,1]
    v_pk_fma_f32 v[36:37], v[38:39], v[20:21], v[36:37] op_sel:[1,1,0] op_sel_hi:[1,0,1] neg_lo:[0,1,0]
    v_cvt_pk_bf16_f32 v7, v34, -v35
    ds_write_b32 v5, v7 offset:7072
    v_cvt_pk_bf16_f32 v6, v38, v39
    ds_write_b32 v5, v6 offset:15776
    v_pk_mul_f32 v[34:35], v[32:33], v[22:23] op_sel:[0,0] op_sel_hi:[0,1]
    v_pk_fma_f32 v[34:35], v[32:33], v[22:23], v[34:35] op_sel:[1,1,0] op_sel_hi:[1,0,1] neg_lo:[0,1,0]
    v_pk_mul_f32 v[38:39], v[36:37], v[20:21] op_sel:[0,0] op_sel_hi:[0,1]
    v_pk_fma_f32 v[38:39], v[36:37], v[20:21], v[38:39] op_sel:[1,1,0] op_sel_hi:[1,0,1] neg_lo:[0,1,0]
    v_cvt_pk_bf16_f32 v7, v32, -v33
    ds_write_b32 v5, v7 offset:7616
    v_cvt_pk_bf16_f32 v6, v36, v37
    ds_write_b32 v5, v6 offset:16320
    v_cvt_pk_bf16_f32 v7, v34, -v35
    ds_write_b32 v5, v7 offset:8160
    v_cvt_pk_bf16_f32 v6, v38, v39
    ds_write_b32 v5, v6 offset:16864
    s_waitcnt vmcnt(18)
    s_cmp_lg_u32 s68, 0
    s_cbranch_scc1 Lnl_5
    s_waitcnt vmcnt(12)
    s_mov_b32 s100, 0
Lng_6:
    v_readfirstlane_b32 s99, v252
    s_add_u32 s100, s100, 1
    s_cmp_lg_u32 s99, 0
    s_cbranch_scc1 Lngd_7
    s_sleep 2
    v_mov_b32_e64 v253, 0
    buffer_load_dword v252, v253, s[52:55], 0 offen sc1
    s_waitcnt vmcnt(0)
    s_cmp_lt_u32 s100, 0x100000
    s_cbranch_scc1 Lng_6
Lngd_7:
    v_mov_b32 v246, 159840
    v_mov_b32_e64 v247, s99
    ds_write_b32 v246, v247
Lnl_5:
    s_waitcnt lgkmcnt(0)
    s_barrier
    s_waitcnt vmcnt(14)
    s_barrier
    s_add_u32 m0, s95, 0
    s_nop 0
    buffer_load_dwordx4 v200, s[44:47], s89 offen lds
    buffer_load_dwordx4 v201, s[44:47], s89 offen offset:1024 lds
    buffer_load_dwordx4 v202, s[56:59], s90 offen offset:2048 lds
    buffer_load_dwordx4 v203, s[56:59], s90 offen offset:3072 lds
    s_add_u32 s89, s89, 64
    s_add_u32 s90, s90, 114688
    s_cmp_eq_u32 s89, s91
    s_cselect_b32 s89, s92, s89
    s_cselect_b32 s90, s93, s90
    s_waitcnt vmcnt(12)
    s_barrier
    s_add_u32 m0, s95, 16384
    s_nop 0
    buffer_load_dwordx4 v200, s[44:47], s89 offen lds
    s_waitcnt lgkmcnt(0)
    s_mul_i32 s97, s79, 4608
    s_add_u32 s97, s97, 150464
    v_and_b32 v18, 3, v0
    v_sub_u32 v18, 3, v18
    v_mul_u32_u24 v18, 4160, v18
    v_lshrrev_b32 v19, 2, v0
    v_and_b32 v19, 3, v19
    v_lshlrev_b32 v19, 3, v19
    v_lshrrev_b32 v17, 4, v0
    v_lshlrev_b32_e64 v17, 4, v17
    buffer_load_dwordx4 v201, s[44:47], s89 offen offset:1024 lds
    v_sub_u32 v18, v18, v19
    v_sub_u32 v18, v18, v17
    s_lshl_b32 s73, s86, 8
    s_sub_u32 s74, s98, s73
    s_add_u32 s74, s74, 328
    v_add_u32 v216, s74, v18
    v_and_b32 v18, 15, v0
    v_lshlrev_b32 v18, 5, v18
    v_sub_u32_e64 v19, v18, v17
    s_sub_u32 s75, s97, s73
    s_add_u32 s75, s75, 336
    v_add_u32_e64 v217, s75, v19
    buffer_load_dwordx4 v202, s[56:59], s90 offen offset:2048 lds
    v_lshrrev_b32_e64 v19, 4, v0
    v_lshl_add_u32 v221, v19, 3, v18
    s_lshl_b32 s73, s86, 11
    s_add_u32 s74, s97, s73
    v_add_u32 v218, s74, v221
    v_lshlrev_b32 v222, 4, v0
    v_add_u32 v223, s74, v222
    v_add_u32 v224, s97, v222
    s_lshl_b32 s74, s86, 12
    s_add_u32 s74, s74, s98
    s_add_u32 s74, s74, 16640
    buffer_load_dwordx4 v203, s[56:59], s90 offen offset:3072 lds
    s_add_u32 s89, s89, 64
    s_add_u32 s90, s90, 114688
    s_cmp_eq_u32 s89, s91
    s_cselect_b32 s89, s92, s89
    s_cselect_b32 s90, s93, s90
    v_add_u32 v219, s74, v222
    s_xor_b32 s75, s86, 1
    s_lshl_b32 s75, s75, 12
    s_add_u32 s75, s75, s98
    s_add_u32 s75, s75, 16640
    v_add_u32 v220, s75, v222
    s_add_u32 s74, s78, s79
    s_lshl_b32 s74, s74, 12
    s_add_u32 s87, s74, s73
    s_add_u32 s88, s87, 0x200000
    v_and_b32 v248, 31, v0
    v_lshlrev_b32 v248, 7, v248
    s_cmp_lg_u32 s68, 0
    s_cbranch_scc1 Lfs_8
    v_mov_b32 v250, s99
    v_mov_b32_e64 v251, 0
    s_mov_b64 exec, 1
    buffer_store_dword v250, v251, s[48:51], s80 offen sc1
    s_mov_b64 exec, -1
Lfs_8:
    s_waitcnt vmcnt(12)
    s_barrier
    s_add_u32 m0, s95, 32768
    s_nop 0
    buffer_load_dwordx4 v200, s[44:47], s89 offen lds
    buffer_load_dwordx4 v201, s[44:47], s89 offen offset:1024 lds
    buffer_load_dwordx4 v202, s[56:59], s90 offen offset:2048 lds
    buffer_load_dwordx4 v203, s[56:59], s90 offen offset:3072 lds
    s_add_u32 s89, s89, 64
    s_add_u32 s90, s90, 114688
    s_cmp_eq_u32 s89, s91
    s_cselect_b32 s89, s92, s89
    s_cselect_b32 s90, s93, s90
    v_mov_b32 v246, 159840
    ds_read_b32 v247, v246
    s_waitcnt lgkmcnt(0)
    v_readfirstlane_b32 s99, v247
    s_waitcnt vmcnt(12)
    s_barrier
    s_add_u32 m0, s95, 49152
    s_nop 0
    s_nop 0
    buffer_load_dwordx4 v200, s[44:47], s89 offen lds
    buffer_load_dwordx4 v201, s[44:47], s89 offen offset:1024 lds
    buffer_load_dwordx4 v202, s[56:59], s90 offen offset:2048 lds
    buffer_load_dwordx4 v203, s[56:59], s90 offen offset:3072 lds
    s_add_u32 s89, s89, 64
    s_add_u32 s90, s90, 114688
    s_cmp_eq_u32 s89, s91
    s_cselect_b32 s89, s92, s89
    s_cselect_b32 s90, s93, s90
    s_waitcnt vmcnt(12)
    s_barrier
    s_add_u32 m0, s95, 65536
    s_nop 0
    s_nop 0
    buffer_load_dwordx4 v200, s[44:47], s89 offen lds
    buffer_load_dwordx4 v201, s[44:47], s89 offen offset:1024 lds
    buffer_load_dwordx4 v202, s[56:59], s90 offen offset:2048 lds
    buffer_load_dwordx4 v203, s[56:59], s90 offen offset:3072 lds
    s_add_u32 s89, s89, 64
    s_add_u32 s90, s90, 114688
    s_cmp_eq_u32 s89, s91
    s_cselect_b32 s89, s92, s89
    s_cselect_b32 s90, s93, s90
    s_waitcnt vmcnt(12)
    s_barrier
    s_add_u32 m0, s95, 0
    s_nop 0
    buffer_load_dwordx4 v200, s[44:47], s89 offen lds
    buffer_load_dwordx4 v201, s[44:47], s89 offen offset:1024 lds
    buffer_load_dwordx4 v202, s[56:59], s90 offen offset:2048 lds
    buffer_load_dwordx4 v203, s[56:59], s90 offen offset:3072 lds
    s_add_u32 s89, s89, 64
    s_add_u32 s90, s90, 114688
    s_cmp_eq_u32 s89, s91
    s_cselect_b32 s89, s92, s89
    s_cselect_b32 s90, s93, s90
    s_waitcnt vmcnt(12)
    s_barrier
    s_add_u32 m0, s95, 16384
    s_nop 0
    s_nop 0
    buffer_load_dwordx4 v200, s[44:47], s89 offen lds
    buffer_load_dwordx4 v201, s[44:47], s89 offen offset:1024 lds
    buffer_load_dwordx4 v202, s[56:59], s90 offen offset:2048 lds
    buffer_load_dwordx4 v203, s[56:59], s90 offen offset:3072 lds
    s_add_u32 s89, s89, 64
    s_add_u32 s90, s90, 114688
    s_cmp_eq_u32 s89, s91
    s_cselect_b32 s89, s92, s89
    s_cselect_b32 s90, s93, s90
    s_waitcnt vmcnt(12)
    s_barrier
    s_add_u32 m0, s95, 32768
    s_nop 0
    s_nop 0
    buffer_load_dwordx4 v200, s[44:47], s89 offen lds
    buffer_load_dwordx4 v201, s[44:47], s89 offen offset:1024 lds
    buffer_load_dwordx4 v202, s[56:59], s90 offen offset:2048 lds
    buffer_load_dwordx4 v203, s[56:59], s90 offen offset:3072 lds
    s_add_u32 s89, s89, 64
    s_add_u32 s90, s90, 114688
    s_cmp_eq_u32 s89, s91
    s_cselect_b32 s89, s92, s89
    s_cselect_b32 s90, s93, s90
    s_waitcnt vmcnt(12)
    s_barrier
    s_add_u32 m0, s95, 49152
    s_nop 0
    s_nop 0
    buffer_load_dwordx4 v200, s[44:47], s89 offen lds
    buffer_load_dwordx4 v201, s[44:47], s89 offen offset:1024 lds
    buffer_load_dwordx4 v202, s[56:59], s90 offen offset:2048 lds
    buffer_load_dwordx4 v203, s[56:59], s90 offen offset:3072 lds
    s_add_u32 s89, s89, 64
    s_add_u32 s90, s90, 114688
    s_cmp_eq_u32 s89, s91
    s_cselect_b32 s89, s92, s89
    s_cselect_b32 s90, s93, s90
    s_cmp_lg_u32 s68, 0
    s_cbranch_scc1 Lxl_9
    buffer_load_dword v249, v248, s[48:51], s81 offen sc1
Lxl_9:
    s_waitcnt vmcnt(12)
    s_barrier
    s_add_u32 m0, s95, 65536
    s_nop 0
    s_nop 0
    buffer_load_dwordx4 v200, s[44:47], s89 offen lds
    buffer_load_dwordx4 v201, s[44:47], s89 offen offset:1024 lds
    buffer_load_dwordx4 v202, s[56:59], s90 offen offset:2048 lds
    buffer_load_dwordx4 v203, s[56:59], s90 offen offset:3072 lds
    s_add_u32 s89, s89, 64
    s_add_u32 s90, s90, 114688
    s_cmp_eq_u32 s89, s91
    s_cselect_b32 s89, s92, s89
    s_cselect_b32 s90, s93, s90
    s_waitcnt vmcnt(12)
    s_barrier
    s_add_u32 m0, s95, 0
    s_nop 0
    buffer_load_dwordx4 v200, s[44:47], s89 offen lds
    buffer_load_dwordx4 v201, s[44:47], s89 offen offset:1024 lds
    buffer_load_dwordx4 v202, s[56:59], s90 offen offset:2048 lds
    buffer_load_dwordx4 v203, s[56:59], s90 offen offset:3072 lds
    s_add_u32 s89, s89, 64
    s_add_u32 s90, s90, 114688
    s_cmp_eq_u32 s89, s91
    s_cselect_b32 s89, s92, s89
    s_cselect_b32 s90, s93, s90
    s_waitcnt vmcnt(12)
    s_barrier
    s_waitcnt vmcnt(8)
    s_cmp_lg_u32 s68, 0
    s_cbranch_scc1 Lxc_10
    s_waitcnt vmcnt(0)
    v_cmp_ne_u32 vcc, s99, v249
    s_mov_b32 s100, 0
    s_nop 0
    s_cmp_eq_u64 vcc, 0
    s_cbranch_scc1 Lfc_11
Lfp_12:
    s_sleep 8
    buffer_load_dword v249, v248, s[48:51], s81 offen sc1
    s_waitcnt vmcnt(0)
    v_cmp_ne_u32 vcc, s99, v249
    s_add_u32 s100, s100, 1
    s_nop 0
    s_cmp_eq_u64 vcc, 0
    s_cbranch_scc1 Lfc_11
    s_cmp_lt_u32 s100, 0x100000
    s_cbranch_scc1 Lfp_12
Lfc_11:
Lxc_10:
    s_barrier
    buffer_load_dwordx4 v[144:147], v222, s[48:51], s87 offen sc1
    buffer_load_dwordx4 v[148:151], v222, s[48:51], s87 offen offset:1024 sc1
    s_waitcnt vmcnt(6)
    s_barrier
    s_waitcnt vmcnt(2)
    s_barrier
    s_barrier
    v_mov_b32 v152, 0
    v_mov_b32 v153, 0
    v_mov_b32 v154, 0
    v_mov_b32 v155, 0
    s_mov_b32 exec_hi, 0
    ds_write_b128 v224, v[152:155]
    s_mov_b64 exec, -1
    s_waitcnt vmcnt(0)
    ds_write_b128 v223, v[144:147] offset:512
    ds_write_b128 v223, v[148:151] offset:1536
    ds_read_b128 v[32:35], v212 offset:0
    ds_read_b128 v[36:39], v212 offset:64
    ds_read_b128 v[40:43], v212 offset:128
    ds_read_b128 v[44:47], v212 offset:192
    ds_read_b128 v[48:51], v212 offset:256
    ds_read_b128 v[52:55], v212 offset:320
    ds_read_b128 v[56:59], v212 offset:384
    ds_read_b128 v[60:63], v212 offset:448
    ds_read_b128 v[64:67], v208 offset:0
    ds_read_b128 v[68:71], v208 offset:64
    ds_read_b128 v[72:75], v208 offset:128
    ds_read_b128 v[76:79], v208 offset:192
    ds_read_b128 v[80:83], v208 offset:256
    ds_read_b128 v[84:87], v208 offset:320
    ds_read_b128 v[88:91], v208 offset:384
    ds_read_b128 v[92:95], v208 offset:448
    ds_read_b128 v[96:99], v209 offset:0
    ds_read_b128 v[100:103], v209 offset:64
    ds_read_b128 v[104:107], v209 offset:128
    ds_read_b128 v[108:111], v209 offset:192
    ds_read_b128 v[112:115], v209 offset:256
    ds_read_b128 v[116:119], v209 offset:320
    ds_read_b128 v[120:123], v209 offset:384
    ds_read_b128 v[124:127], v209 offset:448
    s_waitcnt lgkmcnt(8)
    s_nop 0
    v_mfma_f32_16x16x32_bf16 v[128:131], v[64:67], v[32:35], 0
    v_mfma_f32_16x16x32_bf16 v[128:131], v[68:71], v[36:39], v[128:131]
    v_mfma_f32_16x16x32_bf16 v[128:131], v[72:75], v[40:43], v[128:131]
    v_mfma_f32_16x16x32_bf16 v[128:131], v[76:79], v[44:47], v[128:131]
    v_mfma_f32_16x16x32_bf16 v[128:131], v[80:83], v[48:51], v[128:131]
    v_mfma_f32_16x16x32_bf16 v[128:131], v[84:87], v[52:55], v[128:131]
    v_mfma_f32_16x16x32_bf16 v[128:131], v[88:91], v[56:59], v[128:131]
    v_mfma_f32_16x16x32_bf16 v[128:131], v[92:95], v[60:63], v[128:131]
    s_waitcnt lgkmcnt(0)
    s_nop 0
    v_mfma_f32_16x16x32_bf16 v[132:135], v[96:99], v[32:35], 0
    ds_read_b128 v[64:67], v210 offset:0
    v_mfma_f32_16x16x32_bf16 v[132:135], v[100:103], v[36:39], v[132:135]
    ds_read_b128 v[68:71], v210 offset:64
    v_mfma_f32_16x16x32_bf16 v[132:135], v[104:107], v[40:43], v[132:135]
    ds_read_b128 v[72:75], v210 offset:128
    v_mfma_f32_16x16x32_bf16 v[132:135], v[108:111], v[44:47], v[132:135]
    ds_read_b128 v[76:79], v210 offset:192
    v_mfma_f32_16x16x32_bf16 v[132:135], v[112:115], v[48:51], v[132:135]
    ds_read_b128 v[80:83], v210 offset:256
    v_mfma_f32_16x16x32_bf16 v[132:135], v[116:119], v[52:55], v[132:135]
    ds_read_b128 v[84:87], v210 offset:320
    v_mfma_f32_16x16x32_bf16 v[132:135], v[120:123], v[56:59], v[132:135]
    ds_read_b128 v[88:91], v210 offset:384
    v_mfma_f32_16x16x32_bf16 v[132:135], v[124:127], v[60:63], v[132:135]
    ds_read_b128 v[92:95], v210 offset:448
    s_waitcnt lgkmcnt(0)
    s_nop 0
    v_mfma_f32_16x16x32_bf16 v[136:139], v[64:67], v[32:35], 0
    ds_read_b128 v[96:99], v211 offset:0
    v_mfma_f32_16x16x32_bf16 v[136:139], v[68:71], v[36:39], v[136:139]
    ds_read_b128 v[100:103], v211 offset:64
    v_mfma_f32_16x16x32_bf16 v[136:139], v[72:75], v[40:43], v[136:139]
    ds_read_b128 v[104:107], v211 offset:128
    v_mfma_f32_16x16x32_bf16 v[136:139], v[76:79], v[44:47], v[136:139]
    ds_read_b128 v[108:111], v211 offset:192
    v_mfma_f32_16x16x32_bf16 v[136:139], v[80:83], v[48:51], v[136:139]
    ds_read_b128 v[112:115], v211 offset:256
    v_mfma_f32_16x16x32_bf16 v[136:139], v[84:87], v[52:55], v[136:139]
    ds_read_b128 v[116:119], v211 offset:320
    v_mfma_f32_16x16x32_bf16 v[136:139], v[88:91], v[56:59], v[136:139]
    ds_read_b128 v[120:123], v211 offset:384
    v_mfma_f32_16x16x32_bf16 v[136:139], v[92:95], v[60:63], v[136:139]
    ds_read_b128 v[124:127], v211 offset:448
    s_waitcnt lgkmcnt(0)
    s_nop 0
    v_mfma_f32_16x16x32_bf16 v[140:143], v[96:99], v[32:35], 0
    v_mfma_f32_16x16x32_bf16 v[140:143], v[100:103], v[36:39], v[140:143]
    v_mfma_f32_16x16x32_bf16 v[140:143], v[104:107], v[40:43], v[140:143]
    v_mfma_f32_16x16x32_bf16 v[140:143], v[108:111], v[44:47], v[140:143]
    v_mfma_f32_16x16x32_bf16 v[140:143], v[112:115], v[48:51], v[140:143]
    v_mfma_f32_16x16x32_bf16 v[140:143], v[116:119], v[52:55], v[140:143]
    v_mfma_f32_16x16x32_bf16 v[140:143], v[120:123], v[56:59], v[140:143]
    v_mfma_f32_16x16x32_bf16 v[140:143], v[124:127], v[60:63], v[140:143]
    v_mov_b32 v24, 0
    v_mov_b32 v25, 0
    v_mov_b32 v26, 0
    v_mov_b32_e64 v27, 0
    s_lshl_b32 s100, s68, 2
    s_add_u32 s100, s100, 159784
    v_mov_b32 v246, s100
    v_mov_b32 v247, 1
    ds_write_b32 v246, v247
    v_xor_b32 v246, 4, v246
    s_mov_b32 s101, 0
Lps_13:
    ds_read_b32 v247, v246
    s_add_u32 s101, s101, 1
    s_waitcnt lgkmcnt(0)
    v_readfirstlane_b32 s100, v247
    s_nop 0
    s_cmp_lg_u32 s100, 0
    s_cbranch_scc1 Lpsd_14
    s_cmp_lt_u32 s101, 0x400000
    s_cbranch_scc1 Lps_13
Lpsd_14:
    s_nop 0
    v_cvt_pk_bf16_f32 v40, v128, v129
    v_cvt_pk_bf16_f32 v41, v130, v131
    ds_write_b64 v213, v[40:41] offset:1536
    v_cvt_pk_bf16_f32 v42, v132, v133
    v_cvt_pk_bf16_f32 v43, v134, v135
    ds_write_b64 v213, v[42:43] offset:1024
    v_cvt_pk_bf16_f32 v44, v136, v137
    v_cvt_pk_bf16_f32 v45, v138, v139
    ds_write_b64 v213, v[44:45] offset:512
    v_cvt_pk_bf16_f32 v46, v140, v141
    v_cvt_pk_bf16_f32 v47, v142, v143
    ds_write_b64 v213, v[46:47] offset:0
    s_mov_b64 exec, 0xffff
    ds_write_b128 v214, v[24:27]
    s_mov_b64 exec, -1
    s_waitcnt lgkmcnt(0)
    s_lshl_b32 s100, s68, 2
    s_add_u32 s100, s100, 159800
    v_mov_b32 v246, s100
    v_mov_b32_e64 v247, 1
    ds_write_b32 v246, v247
    v_xor_b32 v246, 4, v246
    s_mov_b32 s101, 0
Lps_15:
    ds_read_b32 v247, v246
    s_add_u32 s101, s101, 1
    s_waitcnt lgkmcnt(0)
    v_readfirstlane_b32 s100, v247
    s_nop 0
    s_cmp_lg_u32 s100, 0
    s_cbranch_scc1 Lpsd_16
    s_cmp_lt_u32 s101, 0x400000
    s_cbranch_scc1 Lps_15
Lpsd_16:
    s_nop 0
    ds_read_b128 v[44:47], v215 offset:0
    ds_read_b64 v[48:49], v215 offset:16
    ds_read_b128 v[64:67], v215 offset:1024
    ds_read_b64 v[68:69], v215 offset:1040
    s_waitcnt lgkmcnt(2)
    s_nop 0
    v_alignbit_b32 v50, v45, v44, 16
    v_alignbit_b32 v51, v46, v45, 16
    v_alignbit_b32 v52, v47, v46, 16
    v_alignbit_b32 v53, v48, v47, 16
    v_mov_b32 v54, v45
    v_mov_b32 v55, v46
    v_mov_b32 v56, v47
    v_mov_b32 v57, v48
    v_alignbit_b32 v58, v46, v45, 16
    v_alignbit_b32 v59, v47, v46, 16
    v_alignbit_b32 v60, v48, v47, 16
    v_alignbit_b32 v61, v49, v48, 16
    ds_write_b128 v215, v[50:53] offset:4160
    ds_write_b128 v215, v[54:57] offset:8320
    ds_write_b128 v215, v[58:61] offset:12480
    s_waitcnt lgkmcnt(3)
    s_nop 0
    v_alignbit_b32 v70, v65, v64, 16
    v_alignbit_b32 v71, v66, v65, 16
    v_alignbit_b32 v72, v67, v66, 16
    v_alignbit_b32 v73, v68, v67, 16
    v_mov_b32 v74, v65
    v_mov_b32 v75, v66
    v_mov_b32 v76, v67
    v_mov_b32 v77, v68
    v_alignbit_b32 v78, v66, v65, 16
    v_alignbit_b32 v79, v67, v66, 16
    v_alignbit_b32 v80, v68, v67, 16
    v_alignbit_b32 v81, v69, v68, 16
    ds_write_b128 v215, v[70:73] offset:5184
    ds_write_b128 v215, v[74:77] offset:9344
    ds_write_b128 v215, v[78:81] offset:13504
    s_waitcnt lgkmcnt(0)
    s_lshl_b32 s100, s68, 2
    s_add_u32 s100, s100, 159752
    v_mov_b32 v246, s100
    v_mov_b32 v247, 1
    ds_write_b32 v246, v247
    v_xor_b32 v246, 4, v246
    s_mov_b32 s101, 0
Lps_17:
    ds_read_b32 v247, v246
    s_add_u32 s101, s101, 1
    s_waitcnt lgkmcnt(0)
    v_readfirstlane_b32 s100, v247
    s_nop 0
    s_cmp_lg_u32 s100, 0
    s_cbranch_scc1 Lpsd_18
    s_cmp_lt_u32 s101, 0x400000
    s_cbranch_scc1 Lps_17
Lpsd_18:
    s_nop 0
    ds_read_b64 v[32:33], v216 offset:3776
    ds_read_b64 v[34:35], v216 offset:3784
    ds_read_b128 v[64:67], v217 offset:192
    ds_read_b64 v[36:37], v216 offset:3264
    ds_read_b64 v[38:39], v216 offset:3272
    ds_read_b128 v[68:71], v217 offset:704
    ds_read_b64 v[40:41], v216 offset:2752
    ds_read_b64 v[42:43], v216 offset:2760
    ds_read_b128 v[72:75], v217 offset:1216
    ds_read_b64 v[44:45], v216 offset:2240
    ds_read_b64 v[46:47], v216 offset:2248
    ds_read_b128 v[76:79], v217 offset:1728
    ds_read_b64 v[48:49], v216 offset:1728
    ds_read_b64 v[50:51], v216 offset:1736
    ds_read_b128 v[80:83], v217 offset:2240
    ds_read_b64 v[52:53], v216 offset:1216
    ds_read_b64 v[54:55], v216 offset:1224
    ds_read_b128 v[84:87], v217 offset:2752
    ds_read_b64 v[56:57], v216 offset:704
    ds_read_b64 v[58:59], v216 offset:712
    ds_read_b128 v[88:91], v217 offset:3264
    ds_read_b64 v[60:61], v216 offset:192
    ds_read_b64 v[62:63], v216 offset:200
    ds_read_b128 v[92:95], v217 offset:3776
    v_mov_b32 v6, s77
    v_mov_b32_e64 v7, s77
    s_waitcnt lgkmcnt(0)
    v_mfma_f32_16x16x32_bf16 v[160:163], v[32:35], v[64:67], 0
    ds_read_b64 v[96:97], v216 offset:3712
    v_mfma_f32_16x16x32_bf16 v[164:167], v[32:35], v[68:71], 0
    ds_read_b64 v[98:99], v216 offset:3720
    v_mfma_f32_16x16x32_bf16 v[168:171], v[32:35], v[72:75], 0
    ds_read_b128 v[128:131], v217 offset:128
    v_mfma_f32_16x16x32_bf16 v[172:175], v[32:35], v[76:79], 0
    ds_read_b64 v[100:101], v216 offset:3200
    v_mfma_f32_16x16x32_bf16 v[176:179], v[32:35], v[80:83], 0
    ds_read_b64 v[102:103], v216 offset:3208
    v_mfma_f32_16x16x32_bf16 v[180:183], v[32:35], v[84:87], 0
    ds_read_b128 v[132:135], v217 offset:640
    v_mfma_f32_16x16x32_bf16 v[184:187], v[32:35], v[88:91], 0
    ds_read_b64 v[104:105], v216 offset:2688
    v_mfma_f32_16x16x32_bf16 v[188:191], v[32:35], v[92:95], 0
    ds_read_b64 v[106:107], v216 offset:2696
    v_mfma_f32_16x16x32_bf16 v[164:167], v[36:39], v[64:67], v[164:167]
    ds_read_b128 v[136:139], v217 offset:1152
    v_mfma_f32_16x16x32_bf16 v[168:171], v[36:39], v[68:71], v[168:171]
    ds_read_b64 v[108:109], v216 offset:2176
    v_mfma_f32_16x16x32_bf16 v[172:175], v[36:39], v[72:75], v[172:175]
    ds_read_b64 v[110:111], v216 offset:2184
    v_mfma_f32_16x16x32_bf16 v[176:179], v[36:39], v[76:79], v[176:179]
    ds_read_b128 v[140:143], v217 offset:1664
    v_mfma_f32_16x16x32_bf16 v[180:183], v[36:39], v[80:83], v[180:183]
    ds_read_b64 v[112:113], v216 offset:1664
    v_mfma_f32_16x16x32_bf16 v[184:187], v[36:39], v[84:87], v[184:187]
    ds_read_b64 v[114:115], v216 offset:1672
    v_mfma_f32_16x16x32_bf16 v[188:191], v[36:39], v[88:91], v[188:191]
    ds_read_b128 v[144:147], v217 offset:2176
    v_mfma_f32_16x16x32_bf16 v[168:171], v[40:43], v[64:67], v[168:171]
    ds_read_b64 v[116:117], v216 offset:1152
    v_mfma_f32_16x16x32_bf16 v[172:175], v[40:43], v[68:71], v[172:175]
    ds_read_b64 v[118:119], v216 offset:1160
    v_mfma_f32_16x16x32_bf16 v[176:179], v[40:43], v[72:75], v[176:179]
    ds_read_b128 v[148:151], v217 offset:2688
    v_mfma_f32_16x16x32_bf16 v[180:183], v[40:43], v[76:79], v[180:183]
    ds_read_b64 v[120:121], v216 offset:640
    v_mfma_f32_16x16x32_bf16 v[184:187], v[40:43], v[80:83], v[184:187]
    ds_read_b64 v[122:123], v216 offset:648
    v_mfma_f32_16x16x32_bf16 v[188:191], v[40:43], v[84:87], v[188:191]
    ds_read_b128 v[152:155], v217 offset:3200
    v_mfma_f32_16x16x32_bf16 v[172:175], v[44:47], v[64:67], v[172:175]
    ds_read_b64 v[124:125], v216 offset:128
    v_mfma_f32_16x16x32_bf16 v[176:179], v[44:47], v[68:71], v[176:179]
    ds_read_b64 v[126:127], v216 offset:136
    v_mfma_f32_16x16x32_bf16 v[180:183], v[44:47], v[72:75], v[180:183]
    ds_read_b128 v[156:159], v217 offset:3712
    v_mfma_f32_16x16x32_bf16 v[184:187], v[44:47], v[76:79], v[184:187]
    v_mfma_f32_16x16x32_bf16 v[188:191], v[44:47], v[80:83], v[188:191]
    v_mfma_f32_16x16x32_bf16 v[176:179], v[48:51], v[64:67], v[176:179]
    v_mfma_f32_16x16x32_bf16 v[180:183], v[48:51], v[68:71], v[180:183]
    v_mfma_f32_16x16x32_bf16 v[184:187], v[48:51], v[72:75], v[184:187]
    v_mfma_f32_16x16x32_bf16 v[188:191], v[48:51], v[76:79], v[188:191]
    v_mfma_f32_16x16x32_bf16 v[180:183], v[52:55], v[64:67], v[180:183]
    v_mfma_f32_16x16x32_bf16 v[184:187], v[52:55], v[68:71], v[184:187]
    v_mfma_f32_16x16x32_bf16 v[188:191], v[52:55], v[72:75], v[188:191]
    v_mfma_f32_16x16x32_bf16 v[184:187], v[56:59], v[64:67], v[184:187]
    v_mfma_f32_16x16x32_bf16 v[188:191], v[56:59], v[68:71], v[188:191]
    v_mfma_f32_16x16x32_bf16 v[188:191], v[60:63], v[64:67], v[188:191]
    s_waitcnt lgkmcnt(0)
    s_nop 0
    v_mfma_f32_16x16x32_bf16 v[160:163], v[96:99], v[128:131], v[160:163]
    ds_read_b64 v[32:33], v216 offset:3648
    v_mfma_f32_16x16x32_bf16 v[164:167], v[96:99], v[132:135], v[164:167]
    ds_read_b64 v[34:35], v216 offset:3656
    v_mfma_f32_16x16x32_bf16 v[168:171], v[96:99], v[136:139], v[168:171]
    ds_read_b128 v[64:67], v217 offset:64
    v_mfma_f32_16x16x32_bf16 v[172:175], v[96:99], v[140:143], v[172:175]
    ds_read_b64 v[36:37], v216 offset:3136
    v_mfma_f32_16x16x32_bf16 v[176:179], v[96:99], v[144:147], v[176:179]
    ds_read_b64 v[38:39], v216 offset:3144
    v_mfma_f32_16x16x32_bf16 v[180:183], v[96:99], v[148:151], v[180:183]
    ds_read_b128 v[68:71], v217 offset:576
    v_mfma_f32_16x16x32_bf16 v[184:187], v[96:99], v[152:155], v[184:187]
    ds_read_b64 v[40:41], v216 offset:2624
    v_mfma_f32_16x16x32_bf16 v[188:191], v[96:99], v[156:159], v[188:191]
    ds_read_b64 v[42:43], v216 offset:2632
    v_mfma_f32_16x16x32_bf16 v[164:167], v[100:103], v[128:131], v[164:167]
    ds_read_b128 v[72:75], v217 offset:1088
    v_mfma_f32_16x16x32_bf16 v[168:171], v[100:103], v[132:135], v[168:171]
    ds_read_b64 v[44:45], v216 offset:2112
    v_mfma_f32_16x16x32_bf16 v[172:175], v[100:103], v[136:139], v[172:175]
    ds_read_b64 v[46:47], v216 offset:2120
    v_mfma_f32_16x16x32_bf16 v[176:179], v[100:103], v[140:143], v[176:179]
    ds_read_b128 v[76:79], v217 offset:1600
    v_mfma_f32_16x16x32_bf16 v[180:183], v[100:103], v[144:147], v[180:183]
    ds_read_b64 v[48:49], v216 offset:1600
    v_mfma_f32_16x16x32_bf16 v[184:187], v[100:103], v[148:151], v[184:187]
    ds_read_b64 v[50:51], v216 offset:1608
    v_mfma_f32_16x16x32_bf16 v[188:191], v[100:103], v[152:155], v[188:191]
    ds_read_b128 v[80:83], v217 offset:2112
    v_mfma_f32_16x16x32_bf16 v[168:171], v[104:107], v[128:131], v[168:171]
    ds_read_b64 v[52:53], v216 offset:1088
    v_mfma_f32_16x16x32_bf16 v[172:175], v[104:107], v[132:135], v[172:175]
    ds_read_b64 v[54:55], v216 offset:1096
    v_mfma_f32_16x16x32_bf16 v[176:179], v[104:107], v[136:139], v[176:179]
    ds_read_b128 v[84:87], v217 offset:2624
    v_mfma_f32_16x16x32_bf16 v[180:183], v[104:107], v[140:143], v[180:183]
    ds_read_b64 v[56:57], v216 offset:576
    v_mfma_f32_16x16x32_bf16 v[184:187], v[104:107], v[144:147], v[184:187]
    ds_read_b64 v[58:59], v216 offset:584
    v_mfma_f32_16x16x32_bf16 v[188:191], v[104:107], v[148:151], v[188:191]
    ds_read_b128 v[88:91], v217 offset:3136
    v_mfma_f32_16x16x32_bf16 v[172:175], v[108:111], v[128:131], v[172:175]
    ds_read_b64 v[60:61], v216 offset:64
    v_mfma_f32_16x16x32_bf16 v[176:179], v[108:111], v[132:135], v[176:179]
    ds_read_b64 v[62:63], v216 offset:72
    v_mfma_f32_16x16x32_bf16 v[180:183], v[108:111], v[136:139], v[180:183]
    ds_read_b128 v[92:95], v217 offset:3648
    v_mfma_f32_16x16x32_bf16 v[184:187], v[108:111], v[140:143], v[184:187]
    v_mfma_f32_16x16x32_bf16 v[188:191], v[108:111], v[144:147], v[188:191]
    v_mfma_f32_16x16x32_bf16 v[176:179], v[112:115], v[128:131], v[176:179]
    v_mfma_f32_16x16x32_bf16 v[180:183], v[112:115], v[132:135], v[180:183]
    v_mfma_f32_16x16x32_bf16 v[184:187], v[112:115], v[136:139], v[184:187]
    v_mfma_f32_16x16x32_bf16 v[188:191], v[112:115], v[140:143], v[188:191]
    v_mfma_f32_16x16x32_bf16 v[180:183], v[116:119], v[128:131], v[180:183]
    v_mfma_f32_16x16x32_bf16 v[184:187], v[116:119], v[132:135], v[184:187]
    v_mfma_f32_16x16x32_bf16 v[188:191], v[116:119], v[136:139], v[188:191]
    v_mfma_f32_16x16x32_bf16 v[184:187], v[120:123], v[128:131], v[184:187]
    v_mfma_f32_16x16x32_bf16 v[188:191], v[120:123], v[132:135], v[188:191]
    v_mfma_f32_16x16x32_bf16 v[188:191], v[124:127], v[128:131], v[188:191]
    s_waitcnt lgkmcnt(0)
    s_nop 0
    v_mfma_f32_16x16x32_bf16 v[160:163], v[32:35], v[64:67], v[160:163]
    ds_read_b64 v[96:97], v216 offset:3584
    v_mfma_f32_16x16x32_bf16 v[164:167], v[32:35], v[68:71], v[164:167]
    ds_read_b64 v[98:99], v216 offset:3592
    v_mfma_f32_16x16x32_bf16 v[168:171], v[32:35], v[72:75], v[168:171]
    ds_read_b128 v[128:131], v217 offset:0
    v_mfma_f32_16x16x32_bf16 v[172:175], v[32:35], v[76:79], v[172:175]
    ds_read_b64 v[100:101], v216 offset:3072
    v_mfma_f32_16x16x32_bf16 v[176:179], v[32:35], v[80:83], v[176:179]
    ds_read_b64 v[102:103], v216 offset:3080
    v_mfma_f32_16x16x32_bf16 v[180:183], v[32:35], v[84:87], v[180:183]
    ds_read_b128 v[132:135], v217 offset:512
    v_mfma_f32_16x16x32_bf16 v[184:187], v[32:35], v[88:91], v[184:187]
    ds_read_b64 v[104:105], v216 offset:2560
    v_mfma_f32_16x16x32_bf16 v[188:191], v[32:35], v[92:95], v[188:191]
    ds_read_b64 v[106:107], v216 offset:2568
    v_mfma_f32_16x16x32_bf16 v[164:167], v[36:39], v[64:67], v[164:167]
    ds_read_b128 v[136:139], v217 offset:1024
    v_mfma_f32_16x16x32_bf16 v[168:171], v[36:39], v[68:71], v[168:171]
    ds_read_b64 v[108:109], v216 offset:2048
    v_mfma_f32_16x16x32_bf16 v[172:175], v[36:39], v[72:75], v[172:175]
    ds_read_b64 v[110:111], v216 offset:2056
    v_mfma_f32_16x16x32_bf16 v[176:179], v[36:39], v[76:79], v[176:179]
    ds_read_b128 v[140:143], v217 offset:1536
    v_mfma_f32_16x16x32_bf16 v[180:183], v[36:39], v[80:83], v[180:183]
    ds_read_b64 v[112:113], v216 offset:1536
    v_mfma_f32_16x16x32_bf16 v[184:187], v[36:39], v[84:87], v[184:187]
    ds_read_b64 v[114:115], v216 offset:1544
    v_mfma_f32_16x16x32_bf16 v[188:191], v[36:39], v[88:91], v[188:191]
    ds_read_b128 v[144:147], v217 offset:2048
    v_mfma_f32_16x16x32_bf16 v[168:171], v[40:43], v[64:67], v[168:171]
    ds_read_b64 v[116:117], v216 offset:1024
    v_mfma_f32_16x16x32_bf16 v[172:175], v[40:43], v[68:71], v[172:175]
    ds_read_b64 v[118:119], v216 offset:1032
    v_mfma_f32_16x16x32_bf16 v[176:179], v[40:43], v[72:75], v[176:179]
    ds_read_b128 v[148:151], v217 offset:2560
    v_mfma_f32_16x16x32_bf16 v[180:183], v[40:43], v[76:79], v[180:183]
    ds_read_b64 v[120:121], v216 offset:512
    v_mfma_f32_16x16x32_bf16 v[184:187], v[40:43], v[80:83], v[184:187]
    ds_read_b64 v[122:123], v216 offset:520
    v_mfma_f32_16x16x32_bf16 v[188:191], v[40:43], v[84:87], v[188:191]
    ds_read_b128 v[152:155], v217 offset:3072
    v_mfma_f32_16x16x32_bf16 v[172:175], v[44:47], v[64:67], v[172:175]
    ds_read_b64 v[124:125], v216 offset:0
    v_mfma_f32_16x16x32_bf16 v[176:179], v[44:47], v[68:71], v[176:179]
    ds_read_b64 v[126:127], v216 offset:8
    v_mfma_f32_16x16x32_bf16 v[180:183], v[44:47], v[72:75], v[180:183]
    ds_read_b128 v[156:159], v217 offset:3584
    v_mfma_f32_16x16x32_bf16 v[184:187], v[44:47], v[76:79], v[184:187]
    v_mfma_f32_16x16x32_bf16 v[188:191], v[44:47], v[80:83], v[188:191]
    v_mfma_f32_16x16x32_bf16 v[176:179], v[48:51], v[64:67], v[176:179]
    v_mfma_f32_16x16x32_bf16 v[180:183], v[48:51], v[68:71], v[180:183]
    v_mfma_f32_16x16x32_bf16 v[184:187], v[48:51], v[72:75], v[184:187]
    v_mfma_f32_16x16x32_bf16 v[188:191], v[48:51], v[76:79], v[188:191]
    v_mfma_f32_16x16x32_bf16 v[180:183], v[52:55], v[64:67], v[180:183]
    v_mfma_f32_16x16x32_bf16 v[184:187], v[52:55], v[68:71], v[184:187]
    v_mfma_f32_16x16x32_bf16 v[188:191], v[52:55], v[72:75], v[188:191]
    v_mfma_f32_16x16x32_bf16 v[184:187], v[56:59], v[64:67], v[184:187]
    v_mfma_f32_16x16x32_bf16 v[188:191], v[56:59], v[68:71], v[188:191]
    v_mfma_f32_16x16x32_bf16 v[188:191], v[60:63], v[64:67], v[188:191]
    s_waitcnt lgkmcnt(0)
    s_nop 0
    v_mfma_f32_16x16x32_bf16 v[160:163], v[96:99], v[128:131], v[160:163]
    v_mfma_f32_16x16x32_bf16 v[164:167], v[96:99], v[132:135], v[164:167]
    v_mfma_f32_16x16x32_bf16 v[168:171], v[96:99], v[136:139], v[168:171]
    v_mfma_f32_16x16x32_bf16 v[172:175], v[96:99], v[140:143], v[172:175]
    v_mfma_f32_16x16x32_bf16 v[176:179], v[96:99], v[144:147], v[176:179]
    v_mfma_f32_16x16x32_bf16 v[180:183], v[96:99], v[148:151], v[180:183]
    v_mfma_f32_16x16x32_bf16 v[184:187], v[96:99], v[152:155], v[184:187]
    v_mfma_f32_16x16x32_bf16 v[188:191], v[96:99], v[156:159], v[188:191]
    v_mfma_f32_16x16x32_bf16 v[164:167], v[100:103], v[128:131], v[164:167]
    v_mfma_f32_16x16x32_bf16 v[168:171], v[100:103], v[132:135], v[168:171]
    v_mfma_f32_16x16x32_bf16 v[172:175], v[100:103], v[136:139], v[172:175]
    v_mfma_f32_16x16x32_bf16 v[176:179], v[100:103], v[140:143], v[176:179]
    v_mfma_f32_16x16x32_bf16 v[180:183], v[100:103], v[144:147], v[180:183]
    v_mfma_f32_16x16x32_bf16 v[184:187], v[100:103], v[148:151], v[184:187]
    v_mfma_f32_16x16x32_bf16 v[188:191], v[100:103], v[152:155], v[188:191]
    v_mfma_f32_16x16x32_bf16 v[168:171], v[104:107], v[128:131], v[168:171]
    v_mfma_f32_16x16x32_bf16 v[172:175], v[104:107], v[132:135], v[172:175]
    v_mfma_f32_16x16x32_bf16 v[176:179], v[104:107], v[136:139], v[176:179]
    v_mfma_f32_16x16x32_bf16 v[180:183], v[104:107], v[140:143], v[180:183]
    v_mfma_f32_16x16x32_bf16 v[184:187], v[104:107], v[144:147], v[184:187]
    v_mfma_f32_16x16x32_bf16 v[188:191], v[104:107], v[148:151], v[188:191]
    v_mfma_f32_16x16x32_bf16 v[172:175], v[108:111], v[128:131], v[172:175]
    v_mfma_f32_16x16x32_bf16 v[176:179], v[108:111], v[132:135], v[176:179]
    v_mfma_f32_16x16x32_bf16 v[180:183], v[108:111], v[136:139], v[180:183]
    v_mfma_f32_16x16x32_bf16 v[184:187], v[108:111], v[140:143], v[184:187]
    v_mfma_f32_16x16x32_bf16 v[188:191], v[108:111], v[144:147], v[188:191]
    v_mfma_f32_16x16x32_bf16 v[176:179], v[112:115], v[128:131], v[176:179]
    v_mfma_f32_16x16x32_bf16 v[180:183], v[112:115], v[132:135], v[180:183]
    v_mfma_f32_16x16x32_bf16 v[184:187], v[112:115], v[136:139], v[184:187]
    v_mfma_f32_16x16x32_bf16 v[188:191], v[112:115], v[140:143], v[188:191]
    v_mfma_f32_16x16x32_bf16 v[180:183], v[116:119], v[128:131], v[180:183]
    v_mfma_f32_16x16x32_bf16 v[184:187], v[116:119], v[132:135], v[184:187]
    v_mfma_f32_16x16x32_bf16 v[188:191], v[116:119], v[136:139], v[188:191]
    v_mfma_f32_16x16x32_bf16 v[184:187], v[120:123], v[128:131], v[184:187]
    v_mfma_f32_16x16x32_bf16 v[188:191], v[120:123], v[132:135], v[188:191]
    v_mfma_f32_16x16x32_bf16 v[188:191], v[124:127], v[128:131], v[188:191]
    ds_read_b64 v[48:49], v218 offset:512
    ds_read_b64 v[50:51], v218 offset:1024
    ds_read_b64 v[52:53], v218 offset:1536
    ds_read_b64 v[54:55], v218 offset:2048
    s_cmp_eq_u32 s86, 0
    s_nop 2
    s_cbranch_scc1 Lx1_19
    s_nop 0
    ds_write_b128 v219, v[160:163] offset:0
    ds_write_b128 v219, v[164:167] offset:1024
    ds_write_b128 v219, v[168:171] offset:2048
    ds_write_b128 v219, v[172:175] offset:3072
    v_mov_b32 v160, v176
    v_mov_b32 v161, v177
    v_mov_b32 v162, v178
    v_mov_b32 v163, v179
    v_mov_b32 v164, v180
    v_mov_b32 v165, v181
    v_mov_b32 v166, v182
    v_mov_b32 v167, v183
    v_mov_b32 v168, v184
    v_mov_b32 v169, v185
    v_mov_b32 v170, v186
    v_mov_b32 v171, v187
    v_mov_b32 v172, v188
    v_mov_b32 v173, v189
    v_mov_b32 v174, v190
    v_mov_b32_e64 v175, v191
    s_branch Lx2_20
Lx1_19:
    ds_write_b128 v219, v[176:179] offset:0
    ds_write_b128 v219, v[180:183] offset:1024
    ds_write_b128 v219, v[184:187] offset:2048
    ds_write_b128 v219, v[188:191] offset:3072
Lx2_20:
    s_waitcnt lgkmcnt(0)
    v_lshlrev_b32 v40, 16, v48
    v_and_b32 v41, 0xffff0000, v48
    v_pk_fma_f32 v[160:161], v[40:41], v[6:7], v[160:161]
    v_lshlrev_b32_e64 v42, 16, v49
    v_and_b32 v43, 0xffff0000, v49
    v_pk_fma_f32 v[162:163], v[42:43], v[6:7], v[162:163]
    v_lshlrev_b32_e64 v40, 16, v50
    v_and_b32 v41, 0xffff0000, v50
    v_pk_fma_f32 v[164:165], v[40:41], v[6:7], v[164:165]
    v_lshlrev_b32_e64 v42, 16, v51
    v_and_b32 v43, 0xffff0000, v51
    v_pk_fma_f32 v[166:167], v[42:43], v[6:7], v[166:167]
    v_lshlrev_b32_e64 v40, 16, v52
    v_and_b32 v41, 0xffff0000, v52
    v_pk_fma_f32 v[168:169], v[40:41], v[6:7], v[168:169]
    v_lshlrev_b32_e64 v42, 16, v53
    v_and_b32 v43, 0xffff0000, v53
    v_pk_fma_f32 v[170:171], v[42:43], v[6:7], v[170:171]
    v_lshlrev_b32_e64 v40, 16, v54
    v_and_b32 v41, 0xffff0000, v54
    v_pk_fma_f32 v[172:173], v[40:41], v[6:7], v[172:173]
    v_lshlrev_b32_e64 v42, 16, v55
    v_and_b32 v43, 0xffff0000, v55
    v_pk_fma_f32 v[174:175], v[42:43], v[6:7], v[174:175]
    s_lshl_b32 s100, s68, 2
    s_add_u32 s100, s100, 159768
    v_mov_b32 v246, s100
    v_mov_b32_e64 v247, 1
    ds_write_b32 v246, v247
    v_xor_b32 v246, 4, v246
    s_mov_b32 s101, 0
Lps_21:
    ds_read_b32 v247, v246
    s_add_u32 s101, s101, 1
    s_waitcnt lgkmcnt(0)
    v_readfirstlane_b32 s100, v247
    s_nop 0
    s_cmp_lg_u32 s100, 0
    s_cbranch_scc1 Lpsd_22
    s_cmp_lt_u32 s101, 0x400000
    s_cbranch_scc1 Lps_21
Lpsd_22:
    s_nop 0
    ds_read_b128 v[32:35], v220 offset:0
    ds_read_b128 v[36:39], v220 offset:1024
    ds_read_b128 v[40:43], v220 offset:2048
    ds_read_b128 v[44:47], v220 offset:3072
    s_waitcnt lgkmcnt(3)
    s_nop 0
    v_pk_add_f32 v[160:161], v[160:161], v[32:33]
    v_pk_add_f32 v[162:163], v[162:163], v[34:35]
    v_cvt_pk_bf16_f32 v56, v160, v161
    v_cvt_pk_bf16_f32 v57, v162, v163
    buffer_store_dwordx2 v[56:57], v221, s[48:51], s88 offen offset:0 sc1
    s_waitcnt lgkmcnt(2)
    s_nop 0
    v_pk_add_f32 v[164:165], v[164:165], v[36:37]
    v_pk_add_f32 v[166:167], v[166:167], v[38:39]
    v_cvt_pk_bf16_f32 v58, v164, v165
    v_cvt_pk_bf16_f32 v59, v166, v167
    buffer_store_dwordx2 v[58:59], v221, s[48:51], s88 offen offset:512 sc1
    s_waitcnt lgkmcnt(1)
    s_nop 0
    v_pk_add_f32 v[168:169], v[168:169], v[40:41]
    v_pk_add_f32 v[170:171], v[170:171], v[42:43]
    v_cvt_pk_bf16_f32 v60, v168, v169
    v_cvt_pk_bf16_f32 v61, v170, v171
    buffer_store_dwordx2 v[60:61], v221, s[48:51], s88 offen offset:1024 sc1
    s_waitcnt lgkmcnt(0)
    s_nop 0
    v_pk_add_f32 v[172:173], v[172:173], v[44:45]
    v_pk_add_f32 v[174:175], v[174:175], v[46:47]
    v_cvt_pk_bf16_f32 v62, v172, v173
    v_cvt_pk_bf16_f32 v63, v174, v175
    buffer_store_dwordx2 v[62:63], v221, s[48:51], s88 offen offset:1536 sc1
    s_waitcnt vmcnt(0)
    v_mov_b32 v246, 159748
    v_mov_b32_e64 v247, 1
    s_mov_b64 exec, 1
    ds_add_rtn_u32 v247, v246, v247
    s_waitcnt lgkmcnt(0)
    s_mov_b64 exec, -1
    v_readfirstlane_b32 s100, v247
    s_nop 0
    s_cmp_lg_u32 s100, 3
    s_cbranch_scc1 Lcp_23
    v_mov_b32 v250, s99
    v_mov_b32_e64 v251, 0
    s_mov_b64 exec, 1
    buffer_store_dword v250, v251, s[48:51], s82 offen sc1
    s_mov_b64 exec, -1
Lcp_23:
    s_barrier
    s_barrier
    s_endpgm
.p2align 3
L_B:
    s_and_b32 s86, s96, 1
    s_lshr_b32 s87, s96, 1
    v_lshrrev_b32 v14, 5, v0
    v_lshlrev_b32 v14, 4, v14
    s_min_u32 s73, s72, 13
    s_lshl_b32 s73, s73, 8
    s_lshl_b32 s74, s86, 7
    s_add_u32 s73, s73, s74
    v_add_u32 v14, s73, v14
    v_and_b32 v12, 31, v0
    v_lshlrev_b32 v12, 6, v12
    s_lshl_b32 s73, s87, 13
    v_add_u32 v12, s73, v12
    v_lshrrev_b32 v13, 5, v0
    v_lshrrev_b32 v1, 2, v0
    v_and_b32 v1, 3, v1
    v_xor_b32_e64 v13, v13, v1
    v_lshl_add_u32 v232, v13, 4, v12
    v_xor_b32 v233, 32, v232
    v_lshrrev_b32 v12, 5, v0
    v_lshlrev_b32_e64 v12, 12, v12
    v_lshl_add_u32 v12, v1, 8, v12
    v_lshrrev_b32 v13, 3, v0
    v_and_b32 v13, 2, v13
    v_and_b32 v234, 1, v0
    v_add_u32 v13, v13, v234
    s_lshl_b32 s73, s86, 3
    v_add_u32 v13, s73, v13
    v_lshlrev_b32 v1, 2, v1
    v_xor_b32 v13, v13, v1
    v_lshl_add_u32 v12, v13, 4, v12
    v_and_b32 v13, 2, v0
    v_lshlrev_b32 v13, 2, v13
    v_add_u32_e64 v12, v12, v13
    v_add_u32 v234, 2048, v12
    v_xor_b32_e64 v235, 64, v234
    v_add_u32 v236, 0x10000, v232
    v_add_u32 v237, 0x10000, v233
    v_add_u32 v238, 0x10000, v234
    v_add_u32 v239, 0x10000, v235
    s_waitcnt lgkmcnt(0)
    s_nop 0
    global_load_dwordx4 v[16:19], v14, s[30:31] offset:0
    global_load_dwordx4 v[20:23], v14, s[30:31] offset:32
    global_load_dwordx4 v[24:27], v14, s[30:31] offset:64
    global_load_dwordx4 v[28:31], v14, s[30:31] offset:96
    s_mov_b32 s44, s8
    s_mov_b32 s45, s9
    s_mov_b32 s46, 0x200000
    s_mov_b32 s47, 0x20000
    s_mov_b32 s48, s42
    s_mov_b32 s49, s43
    s_mov_b32 s50, 0x2000000
    s_mov_b32 s51, 0x20000
    s_mov_b32 s52, s40
    s_mov_b32 s53, s41
    s_mov_b32 s54, 0x100
    s_mov_b32 s55, 0x20000
    s_mov_b32 s60, s32
    s_mov_b32 s61, s33
    s_mov_b32 s62, 0x1c0000
    s_mov_b32 s63, 0x20000
    s_mov_b32 s64, s38
    s_mov_b32 s65, s39
    s_mov_b32 s66, 0x200000
    s_mov_b32 s67, 0x20000
    s_lshl_b32 s81, s69, 12
    s_lshl_b32 s73, s70, 7
    s_add_u32 s82, s81, s73
    s_nop 0
    s_add_u32 s80, s82, 0xc00000
    s_add_u32 s82, s82, 0xc08000
    s_add_u32 s81, s81, 0xc00000
    s_lshl_b32 s85, s71, 11
    s_add_u32 s85, s85, 0xc10000
    s_lshl_b32 s73, s72, 7
    s_add_u32 s84, s85, s73
    s_and_b32 s73, s70, 7
    s_lshl_b32 s83, s73, 12
    s_add_u32 s83, s83, 0xc08000
    s_and_b32 s89, s70, 7
    s_mul_i32 s75, s89, 3
    s_lshl_b32 s89, s89, 7
    s_mul_i32 s98, s96, 20480
    s_mul_i32 s91, s96, 458752
    s_add_u32 s91, s91, s89
    s_add_u32 s92, s91, 458752
    s_lshl_b32 s73, s75, 14
    s_add_u32 s90, s91, s73
    v_lshrrev_b32 v14, 3, v0
    v_lshlrev_b32 v14, 10, v14
    v_lshrrev_b32 v15, 2, v0
    v_and_b32 v15, 4, v15
    v_xor_b32 v15, v15, v0
    v_and_b32_e64 v15, 7, v15
    v_lshl_add_u32 v2, v15, 4, v14
    v_add_u32 v3, 7168, v2
    s_lshl_b32 s88, s69, 8
    s_lshr_b32 s73, s70, 3
    s_lshl_b32 s73, s73, 6
    s_add_u32 s88, s88, s73
    s_lshr_b32 s73, s88, 5
    s_mul_i32 s73, s73, 112
    s_mul_i32 s74, s96, 28
    s_add_u32 s73, s73, s74
    s_lshl_b32 s73, s73, 10
    s_add_u32 s95, s73, 0x500000
    s_add_u32 s97, s95, 28672
    s_lshl_b32 s73, s75, 10
    s_add_u32 s93, s95, s73
    s_mul_i32 s73, s86, 114688
    v_lshlrev_b32 v14, 4, v0
    v_add_u32 v4, s73, v14
    s_sub_u32 s73, 114688, s73
    v_add_u32 v5, s73, v14
    v_lshrrev_b32 v14, 5, v0
    v_lshlrev_b32 v14, 3, v14
    v_lshrrev_b32 v1, 2, v0
    v_and_b32 v1, 3, v1
    v_add_u32 v14, v14, v1
    v_lshlrev_b32 v14, 7, v14
    v_lshrrev_b32 v15, 3, v0
    v_and_b32 v15, 2, v15
    v_and_b32 v6, 1, v0
    v_add_u32 v15, v15, v6
    s_lshl_b32 s73, s87, 2
    v_add_u32 v15, s73, v15
    v_lshlrev_b32 v1, 1, v1
    v_and_b32 v1, 4, v1
    v_xor_b32 v15, v15, v1
    v_lshl_add_u32 v14, v15, 4, v14
    v_and_b32 v15, 2, v0
    v_lshlrev_b32 v15, 2, v15
    v_add_u32 v14, v14, v15
    v_add_u32 v6, s98, v14
    v_xor_b32 v7, 64, v6
    v_lshrrev_b32 v14, 2, v0
    v_lshlrev_b32 v8, 12, v14
    v_and_b32 v15, 3, v0
    v_lshl_add_u32 v8, v15, 4, v8
    v_mul_u32_u24 v11, 80, v14
    v_lshl_add_u32 v11, v15, 4, v11
    s_mul_i32 s79, s96, 2560
    s_add_u32 s79, s79, 65536
    v_add_u32 v11, s79, v11
    v_lshrrev_b32 v14, 5, v0
    v_lshlrev_b32 v14, 3, v14
    v_lshrrev_b32 v1, 2, v0
    v_and_b32 v1, 3, v1
    v_add_u32 v14, v14, v1
    v_mul_u32_u24 v14, 80, v14
    v_lshrrev_b32 v1, 4, v0
    v_and_b32 v1, 1, v1
    v_lshl_add_u32 v14, v1, 5, v14
    v_lshl_add_u32 v14, v15, 3, v14
    v_add_u32 v12, s79, v14
    v_and_b32 v9, 31, v0
    v_lshlrev_b32 v10, 10, v9
    v_lshlrev_b32 v9, 2, v9
    v_lshrrev_b32_e64 v15, 5, v0
    v_lshl_add_u32 v10, v15, 4, v10
    s_lshr_b32 s73, s89, 1
    s_lshl_b32 s74, s87, 5
    s_add_u32 s73, s73, s74
    s_lshl_b32 s76, s73, 12
    s_lshl_b32 s74, s86, 5
    s_add_u32 s74, s74, s88
    s_lshl_b32 s75, s74, 1
    s_add_u32 s76, s76, s75
    s_add_u32 s76, s76, 0x200000
    s_lshl_b32 s77, s74, 2
    s_add_u32 s77, s77, 0x400000
    s_lshl_b32 s78, s74, 10
    s_lshl_b32 s75, s87, 6
    s_add_u32 s78, s78, s75
    s_add_u32 s78, s78, s89
    v_lshrrev_b32 v15, 5, v0
    v_lshlrev_b32 v15, 4, v15
    s_lshl_b32 s73, s87, 6
    s_add_u32 s73, s73, s89
    v_add_u32 v15, s73, v15
    global_load_dwordx4 v[240:243], v15, s[34:35] offset:0
    global_load_dwordx4 v[244:247], v15, s[34:35] offset:32
    s_getreg_b32 s100, hwreg(HW_REG_XCC_ID)
    s_and_b32 s100, s100, 7
    s_lshl_b32 s5, s100, 3
    s_cmp_lg_u32 s68, 4
    s_cbranch_scc1 Lreg_24
    s_lshl_b64 s[100:101], 1, s5
    v_mov_b32 v14, s100
    v_mov_b32_e64 v15, s101
    s_lshl_b32 s100, s71, 3
    s_add_u32 s100, s100, 128
    v_mov_b32 v1, s100
    s_mov_b64 exec, 1
    buffer_atomic_add_x2 v[14:15], v1, s[52:55], 0 offen sc1
    s_mov_b64 exec, -1
Lreg_24:
    s_mov_b32 s56, s28
    s_mov_b32 s57, s29
    s_mov_b32 s58, 0x1c0000
    s_mov_b32 s59, 0x20000
    v_lshlrev_b32 v15, 7, v0
    s_mul_i32 s73, s70, 57344
    s_lshl_b32 s74, s96, 13
    s_add_u32 s73, s73, s74
    s_and_b32 s75, s71, 1
    s_lshl_b32 s75, s75, 3
    s_add_u32 s75, s75, s72
    s_add_u32 s75, s75, s96
    s_add_u32 s75, s75, 5
    s_and_b32 s75, s75, 15
    s_mul_i32 s75, s75, 114688
    s_lshl_b32 s100, s72, 8
    s_add_u32 s75, s75, s100
    v_lshrrev_b32_e64 v48, 1, v0
    v_mul_u32_u24 v48, 3584, v48
    v_and_b32_e64 v49, 1, v0
    v_lshl_add_u32 v48, v49, 7, v48
    buffer_load_dword v50, v48, s[56:59], s75 offen
    s_add_u32 s74, s73, 32768
    s_cmp_eq_u32 s96, 3
    s_cselect_b32 s74, 0x40000000, s74
    s_mov_b32 s6, s73
    s_mov_b32 s7, s74
    v_lshlrev_b32 v49, 7, v0
    s_cmp_eq_u32 s94, 1
    s_cbranch_scc1 Lgate_25
    s_waitcnt vmcnt(3)
    v_lshlrev_b32_e64 v128, 16, v16
    v_and_b32 v129, 0xffff0000, v16
    v_lshlrev_b32_e64 v130, 16, v17
    v_and_b32 v131, 0xffff0000, v17
    v_lshlrev_b32_e64 v132, 16, v18
    v_and_b32 v133, 0xffff0000, v18
    v_lshlrev_b32_e64 v134, 16, v19
    v_and_b32 v135, 0xffff0000, v19
    v_lshlrev_b32_e64 v136, 16, v20
    v_and_b32 v137, 0xffff0000, v20
    v_lshlrev_b32_e64 v138, 16, v21
    v_and_b32 v139, 0xffff0000, v21
    v_lshlrev_b32_e64 v140, 16, v22
    v_and_b32 v141, 0xffff0000, v22
    v_lshlrev_b32_e64 v142, 16, v23
    v_and_b32 v143, 0xffff0000, v23
    v_lshlrev_b32_e64 v144, 16, v16
    v_and_b32 v145, 0xffff0000, v16
    v_lshlrev_b32_e64 v146, 16, v17
    v_and_b32 v147, 0xffff0000, v17
    v_lshlrev_b32_e64 v148, 16, v18
    v_and_b32 v149, 0xffff0000, v18
    v_lshlrev_b32_e64 v150, 16, v19
    v_and_b32 v151, 0xffff0000, v19
    v_lshlrev_b32_e64 v152, 16, v20
    v_and_b32 v153, 0xffff0000, v20
    v_lshlrev_b32_e64 v154, 16, v21
    v_and_b32 v155, 0xffff0000, v21
    v_lshlrev_b32_e64 v156, 16, v22
    v_and_b32 v157, 0xffff0000, v22
    v_lshlrev_b32_e64 v158, 16, v23
    v_and_b32 v159, 0xffff0000, v23
    v_lshlrev_b32_e64 v160, 16, v24
    v_and_b32 v161, 0xffff0000, v24
    v_lshlrev_b32_e64 v162, 16, v25
    v_and_b32 v163, 0xffff0000, v25
    v_lshlrev_b32_e64 v164, 16, v26
    v_and_b32 v165, 0xffff0000, v26
    v_lshlrev_b32_e64 v166, 16, v27
    v_and_b32 v167, 0xffff0000, v27
    v_lshlrev_b32_e64 v168, 16, v28
    v_and_b32 v169, 0xffff0000, v28
    v_lshlrev_b32_e64 v170, 16, v29
    v_and_b32 v171, 0xffff0000, v29
    v_lshlrev_b32_e64 v172, 16, v30
    v_and_b32 v173, 0xffff0000, v30
    v_lshlrev_b32_e64 v174, 16, v31
    v_and_b32 v175, 0xffff0000, v31
    v_lshlrev_b32_e64 v176, 16, v24
    v_and_b32 v177, 0xffff0000, v24
    v_lshlrev_b32_e64 v178, 16, v25
    v_and_b32 v179, 0xffff0000, v25
    v_lshlrev_b32_e64 v180, 16, v26
    v_and_b32 v181, 0xffff0000, v26
    v_lshlrev_b32_e64 v182, 16, v27
    v_and_b32 v183, 0xffff0000, v27
    v_lshlrev_b32_e64 v184, 16, v28
    v_and_b32 v185, 0xffff0000, v28
    v_lshlrev_b32_e64 v186, 16, v29
    v_and_b32 v187, 0xffff0000, v29
    v_lshlrev_b32_e64 v188, 16, v30
    v_and_b32 v189, 0xffff0000, v30
    v_lshlrev_b32_e64 v190, 16, v31
    v_and_b32 v191, 0xffff0000, v31
    s_barrier
    s_nop 0
    ds_read_b64_tr_b16 v[64:65], v234 offset:0
    ds_read_b64_tr_b16 v[66:67], v234 offset:1024
    ds_read_b64_tr_b16 v[72:73], v235 offset:0
    ds_read_b64_tr_b16 v[74:75], v235 offset:1024
    ds_read_b128 v[80:83], v232 offset:0
    ds_read_b128 v[88:91], v232 offset:4096
    ds_read_b64_tr_b16 v[68:69], v234 offset:8192
    ds_read_b64_tr_b16 v[70:71], v234 offset:9216
    ds_read_b64_tr_b16 v[76:77], v235 offset:8192
    ds_read_b64_tr_b16 v[78:79], v235 offset:9216
    ds_read_b128 v[84:87], v233 offset:0
    ds_read_b128 v[92:95], v233 offset:4096
    s_waitcnt lgkmcnt(0)
    s_barrier
    v_mfma_f32_32x32x16_bf16 v[128:143], v[64:67], v[80:83], v[128:143]
    ds_read_b64_tr_b16 v[96:97], v234 offset:16384
    ds_read_b64_tr_b16 v[98:99], v234 offset:17408
    v_mfma_f32_32x32x16_bf16 v[144:159], v[64:67], v[88:91], v[144:159]
    ds_read_b64_tr_b16 v[104:105], v235 offset:16384
    ds_read_b64_tr_b16 v[106:107], v235 offset:17408
    v_mfma_f32_32x32x16_bf16 v[160:175], v[72:75], v[80:83], v[160:175]
    ds_read_b128 v[112:115], v232 offset:16384
    ds_read_b128 v[120:123], v232 offset:20480
    v_mfma_f32_32x32x16_bf16 v[176:191], v[72:75], v[88:91], v[176:191]
    ds_read_b64_tr_b16 v[100:101], v234 offset:24576
    ds_read_b64_tr_b16 v[102:103], v234 offset:25600
    v_mfma_f32_32x32x16_bf16 v[128:143], v[68:71], v[84:87], v[128:143]
    ds_read_b64_tr_b16 v[108:109], v235 offset:24576
    ds_read_b64_tr_b16 v[110:111], v235 offset:25600
    v_mfma_f32_32x32x16_bf16 v[144:159], v[68:71], v[92:95], v[144:159]
    ds_read_b128 v[116:119], v233 offset:16384
    ds_read_b128 v[124:127], v233 offset:20480
    v_mfma_f32_32x32x16_bf16 v[160:175], v[76:79], v[84:87], v[160:175]
    v_mfma_f32_32x32x16_bf16 v[176:191], v[76:79], v[92:95], v[176:191]
    s_waitcnt lgkmcnt(0)
    s_barrier
    v_mfma_f32_32x32x16_bf16 v[128:143], v[96:99], v[112:115], v[128:143]
    ds_read_b64_tr_b16 v[64:65], v234 offset:32768
    ds_read_b64_tr_b16 v[66:67], v234 offset:33792
    v_mfma_f32_32x32x16_bf16 v[144:159], v[96:99], v[120:123], v[144:159]
    ds_read_b64_tr_b16 v[72:73], v235 offset:32768
    ds_read_b64_tr_b16 v[74:75], v235 offset:33792
    v_mfma_f32_32x32x16_bf16 v[160:175], v[104:107], v[112:115], v[160:175]
    ds_read_b128 v[80:83], v232 offset:32768
    ds_read_b128 v[88:91], v232 offset:36864
    v_mfma_f32_32x32x16_bf16 v[176:191], v[104:107], v[120:123], v[176:191]
    ds_read_b64_tr_b16 v[68:69], v234 offset:40960
    ds_read_b64_tr_b16 v[70:71], v234 offset:41984
    v_mfma_f32_32x32x16_bf16 v[128:143], v[100:103], v[116:119], v[128:143]
    ds_read_b64_tr_b16 v[76:77], v235 offset:40960
    ds_read_b64_tr_b16 v[78:79], v235 offset:41984
    v_mfma_f32_32x32x16_bf16 v[144:159], v[100:103], v[124:127], v[144:159]
    ds_read_b128 v[84:87], v233 offset:32768
    ds_read_b128 v[92:95], v233 offset:36864
    v_mfma_f32_32x32x16_bf16 v[160:175], v[108:111], v[116:119], v[160:175]
    v_mfma_f32_32x32x16_bf16 v[176:191], v[108:111], v[124:127], v[176:191]
    s_waitcnt lgkmcnt(0)
    s_barrier
    v_mfma_f32_32x32x16_bf16 v[128:143], v[64:67], v[80:83], v[128:143]
    ds_read_b64_tr_b16 v[96:97], v234 offset:49152
    ds_read_b64_tr_b16 v[98:99], v234 offset:50176
    v_mfma_f32_32x32x16_bf16 v[144:159], v[64:67], v[88:91], v[144:159]
    ds_read_b64_tr_b16 v[104:105], v235 offset:49152
    ds_read_b64_tr_b16 v[106:107], v235 offset:50176
    v_mfma_f32_32x32x16_bf16 v[160:175], v[72:75], v[80:83], v[160:175]
    ds_read_b128 v[112:115], v232 offset:49152
    ds_read_b128 v[120:123], v232 offset:53248
    v_mfma_f32_32x32x16_bf16 v[176:191], v[72:75], v[88:91], v[176:191]
    ds_read_b64_tr_b16 v[100:101], v234 offset:57344
    ds_read_b64_tr_b16 v[102:103], v234 offset:58368
    v_mfma_f32_32x32x16_bf16 v[128:143], v[68:71], v[84:87], v[128:143]
    ds_read_b64_tr_b16 v[108:109], v235 offset:57344
    ds_read_b64_tr_b16 v[110:111], v235 offset:58368
    v_mfma_f32_32x32x16_bf16 v[144:159], v[68:71], v[92:95], v[144:159]
    ds_read_b128 v[116:119], v233 offset:49152
    ds_read_b128 v[124:127], v233 offset:53248
    v_mfma_f32_32x32x16_bf16 v[160:175], v[76:79], v[84:87], v[160:175]
    v_mfma_f32_32x32x16_bf16 v[176:191], v[76:79], v[92:95], v[176:191]
    s_waitcnt lgkmcnt(0)
    s_barrier
    v_mfma_f32_32x32x16_bf16 v[128:143], v[96:99], v[112:115], v[128:143]
    ds_read_b64_tr_b16 v[64:65], v238 offset:0
    ds_read_b64_tr_b16 v[66:67], v238 offset:1024
    v_mfma_f32_32x32x16_bf16 v[144:159], v[96:99], v[120:123], v[144:159]
    ds_read_b64_tr_b16 v[72:73], v239 offset:0
    ds_read_b64_tr_b16 v[74:75], v239 offset:1024
    v_mfma_f32_32x32x16_bf16 v[160:175], v[104:107], v[112:115], v[160:175]
    ds_read_b128 v[80:83], v236 offset:0
    ds_read_b128 v[88:91], v236 offset:4096
    v_mfma_f32_32x32x16_bf16 v[176:191], v[104:107], v[120:123], v[176:191]
    ds_read_b64_tr_b16 v[68:69], v238 offset:8192
    ds_read_b64_tr_b16 v[70:71], v238 offset:9216
    v_mfma_f32_32x32x16_bf16 v[128:143], v[100:103], v[116:119], v[128:143]
    ds_read_b64_tr_b16 v[76:77], v239 offset:8192
    ds_read_b64_tr_b16 v[78:79], v239 offset:9216
    v_mfma_f32_32x32x16_bf16 v[144:159], v[100:103], v[124:127], v[144:159]
    ds_read_b128 v[84:87], v237 offset:0
    ds_read_b128 v[92:95], v237 offset:4096
    v_mfma_f32_32x32x16_bf16 v[160:175], v[108:111], v[116:119], v[160:175]
    v_mfma_f32_32x32x16_bf16 v[176:191], v[108:111], v[124:127], v[176:191]
    s_waitcnt lgkmcnt(0)
    s_barrier
    v_mfma_f32_32x32x16_bf16 v[128:143], v[64:67], v[80:83], v[128:143]
    ds_read_b64_tr_b16 v[96:97], v234 offset:0
    ds_read_b64_tr_b16 v[98:99], v234 offset:1024
    v_mfma_f32_32x32x16_bf16 v[144:159], v[64:67], v[88:91], v[144:159]
    ds_read_b64_tr_b16 v[104:105], v235 offset:0
    ds_read_b64_tr_b16 v[106:107], v235 offset:1024
    v_mfma_f32_32x32x16_bf16 v[160:175], v[72:75], v[80:83], v[160:175]
    ds_read_b128 v[112:115], v232 offset:0
    ds_read_b128 v[120:123], v232 offset:4096
    v_mfma_f32_32x32x16_bf16 v[176:191], v[72:75], v[88:91], v[176:191]
    ds_read_b64_tr_b16 v[100:101], v234 offset:8192
    ds_read_b64_tr_b16 v[102:103], v234 offset:9216
    v_mfma_f32_32x32x16_bf16 v[128:143], v[68:71], v[84:87], v[128:143]
    ds_read_b64_tr_b16 v[108:109], v235 offset:8192
    ds_read_b64_tr_b16 v[110:111], v235 offset:9216
    v_mfma_f32_32x32x16_bf16 v[144:159], v[68:71], v[92:95], v[144:159]
    ds_read_b128 v[116:119], v233 offset:0
    ds_read_b128 v[124:127], v233 offset:4096
    v_mfma_f32_32x32x16_bf16 v[160:175], v[76:79], v[84:87], v[160:175]
    v_mfma_f32_32x32x16_bf16 v[176:191], v[76:79], v[92:95], v[176:191]
    s_waitcnt lgkmcnt(0)
    s_barrier
    v_mfma_f32_32x32x16_bf16 v[128:143], v[96:99], v[112:115], v[128:143]
    ds_read_b64_tr_b16 v[64:65], v234 offset:16384
    ds_read_b64_tr_b16 v[66:67], v234 offset:17408
    v_mfma_f32_32x32x16_bf16 v[144:159], v[96:99], v[120:123], v[144:159]
    ds_read_b64_tr_b16 v[72:73], v235 offset:16384
    ds_read_b64_tr_b16 v[74:75], v235 offset:17408
    v_mfma_f32_32x32x16_bf16 v[160:175], v[104:107], v[112:115], v[160:175]
    ds_read_b128 v[80:83], v232 offset:16384
    ds_read_b128 v[88:91], v232 offset:20480
    v_mfma_f32_32x32x16_bf16 v[176:191], v[104:107], v[120:123], v[176:191]
    ds_read_b64_tr_b16 v[68:69], v234 offset:24576
    ds_read_b64_tr_b16 v[70:71], v234 offset:25600
    v_mfma_f32_32x32x16_bf16 v[128:143], v[100:103], v[116:119], v[128:143]
    ds_read_b64_tr_b16 v[76:77], v235 offset:24576
    ds_read_b64_tr_b16 v[78:79], v235 offset:25600
    v_mfma_f32_32x32x16_bf16 v[144:159], v[100:103], v[124:127], v[144:159]
    ds_read_b128 v[84:87], v233 offset:16384
    ds_read_b128 v[92:95], v233 offset:20480
    v_mfma_f32_32x32x16_bf16 v[160:175], v[108:111], v[116:119], v[160:175]
    v_mfma_f32_32x32x16_bf16 v[176:191], v[108:111], v[124:127], v[176:191]
    s_waitcnt lgkmcnt(0)
    s_barrier
    v_mfma_f32_32x32x16_bf16 v[128:143], v[64:67], v[80:83], v[128:143]
    ds_read_b64_tr_b16 v[96:97], v234 offset:32768
    ds_read_b64_tr_b16 v[98:99], v234 offset:33792
    v_mfma_f32_32x32x16_bf16 v[144:159], v[64:67], v[88:91], v[144:159]
    ds_read_b64_tr_b16 v[104:105], v235 offset:32768
    ds_read_b64_tr_b16 v[106:107], v235 offset:33792
    v_mfma_f32_32x32x16_bf16 v[160:175], v[72:75], v[80:83], v[160:175]
    ds_read_b128 v[112:115], v232 offset:32768
    ds_read_b128 v[120:123], v232 offset:36864
    v_mfma_f32_32x32x16_bf16 v[176:191], v[72:75], v[88:91], v[176:191]
    ds_read_b64_tr_b16 v[100:101], v234 offset:40960
    ds_read_b64_tr_b16 v[102:103], v234 offset:41984
    v_mfma_f32_32x32x16_bf16 v[128:143], v[68:71], v[84:87], v[128:143]
    ds_read_b64_tr_b16 v[108:109], v235 offset:40960
    ds_read_b64_tr_b16 v[110:111], v235 offset:41984
    v_mfma_f32_32x32x16_bf16 v[144:159], v[68:71], v[92:95], v[144:159]
    ds_read_b128 v[116:119], v233 offset:32768
    ds_read_b128 v[124:127], v233 offset:36864
    v_mfma_f32_32x32x16_bf16 v[160:175], v[76:79], v[84:87], v[160:175]
    v_mfma_f32_32x32x16_bf16 v[176:191], v[76:79], v[92:95], v[176:191]
    s_waitcnt lgkmcnt(0)
    s_barrier
    v_mfma_f32_32x32x16_bf16 v[128:143], v[96:99], v[112:115], v[128:143]
    ds_read_b64_tr_b16 v[64:65], v234 offset:49152
    ds_read_b64_tr_b16 v[66:67], v234 offset:50176
    v_mfma_f32_32x32x16_bf16 v[144:159], v[96:99], v[120:123], v[144:159]
    ds_read_b64_tr_b16 v[72:73], v235 offset:49152
    ds_read_b64_tr_b16 v[74:75], v235 offset:50176
    v_mfma_f32_32x32x16_bf16 v[160:175], v[104:107], v[112:115], v[160:175]
    ds_read_b128 v[80:83], v232 offset:49152
    ds_read_b128 v[88:91], v232 offset:53248
    v_mfma_f32_32x32x16_bf16 v[176:191], v[104:107], v[120:123], v[176:191]
    ds_read_b64_tr_b16 v[68:69], v234 offset:57344
    ds_read_b64_tr_b16 v[70:71], v234 offset:58368
    v_mfma_f32_32x32x16_bf16 v[128:143], v[100:103], v[116:119], v[128:143]
    ds_read_b64_tr_b16 v[76:77], v235 offset:57344
    ds_read_b64_tr_b16 v[78:79], v235 offset:58368
    v_mfma_f32_32x32x16_bf16 v[144:159], v[100:103], v[124:127], v[144:159]
    ds_read_b128 v[84:87], v233 offset:49152
    ds_read_b128 v[92:95], v233 offset:53248
    v_mfma_f32_32x32x16_bf16 v[160:175], v[108:111], v[116:119], v[160:175]
    v_mfma_f32_32x32x16_bf16 v[176:191], v[108:111], v[124:127], v[176:191]
    s_waitcnt lgkmcnt(0)
    s_barrier
    v_mfma_f32_32x32x16_bf16 v[128:143], v[64:67], v[80:83], v[128:143]
    ds_read_b64_tr_b16 v[96:97], v238 offset:0
    ds_read_b64_tr_b16 v[98:99], v238 offset:1024
    v_mfma_f32_32x32x16_bf16 v[144:159], v[64:67], v[88:91], v[144:159]
    ds_read_b64_tr_b16 v[104:105], v239 offset:0
    ds_read_b64_tr_b16 v[106:107], v239 offset:1024
    v_mfma_f32_32x32x16_bf16 v[160:175], v[72:75], v[80:83], v[160:175]
    ds_read_b128 v[112:115], v236 offset:0
    ds_read_b128 v[120:123], v236 offset:4096
    v_mfma_f32_32x32x16_bf16 v[176:191], v[72:75], v[88:91], v[176:191]
    ds_read_b64_tr_b16 v[100:101], v238 offset:8192
    ds_read_b64_tr_b16 v[102:103], v238 offset:9216
    v_mfma_f32_32x32x16_bf16 v[128:143], v[68:71], v[84:87], v[128:143]
    ds_read_b64_tr_b16 v[108:109], v239 offset:8192
    ds_read_b64_tr_b16 v[110:111], v239 offset:9216
    v_mfma_f32_32x32x16_bf16 v[144:159], v[68:71], v[92:95], v[144:159]
    ds_read_b128 v[116:119], v237 offset:0
    ds_read_b128 v[124:127], v237 offset:4096
    v_mfma_f32_32x32x16_bf16 v[160:175], v[76:79], v[84:87], v[160:175]
    v_mfma_f32_32x32x16_bf16 v[176:191], v[76:79], v[92:95], v[176:191]
    s_waitcnt lgkmcnt(0)
    s_barrier
    v_mfma_f32_32x32x16_bf16 v[128:143], v[96:99], v[112:115], v[128:143]
    ds_read_b64_tr_b16 v[64:65], v234 offset:0
    ds_read_b64_tr_b16 v[66:67], v234 offset:1024
    v_mfma_f32_32x32x16_bf16 v[144:159], v[96:99], v[120:123], v[144:159]
    ds_read_b64_tr_b16 v[72:73], v235 offset:0
    ds_read_b64_tr_b16 v[74:75], v235 offset:1024
    v_mfma_f32_32x32x16_bf16 v[160:175], v[104:107], v[112:115], v[160:175]
    ds_read_b128 v[80:83], v232 offset:0
    ds_read_b128 v[88:91], v232 offset:4096
    v_mfma_f32_32x32x16_bf16 v[176:191], v[104:107], v[120:123], v[176:191]
    ds_read_b64_tr_b16 v[68:69], v234 offset:8192
    ds_read_b64_tr_b16 v[70:71], v234 offset:9216
    v_mfma_f32_32x32x16_bf16 v[128:143], v[100:103], v[116:119], v[128:143]
    ds_read_b64_tr_b16 v[76:77], v235 offset:8192
    ds_read_b64_tr_b16 v[78:79], v235 offset:9216
    v_mfma_f32_32x32x16_bf16 v[144:159], v[100:103], v[124:127], v[144:159]
    ds_read_b128 v[84:87], v233 offset:0
    ds_read_b128 v[92:95], v233 offset:4096
    v_mfma_f32_32x32x16_bf16 v[160:175], v[108:111], v[116:119], v[160:175]
    v_mfma_f32_32x32x16_bf16 v[176:191], v[108:111], v[124:127], v[176:191]
    s_lshl_b32 s100, s71, 3
    s_add_u32 s100, s100, 128
    v_mov_b32 v1, s100
    buffer_load_dwordx2 v[52:53], v1, s[52:55], 0 offen sc1
    s_waitcnt lgkmcnt(0)
    s_barrier
    v_mfma_f32_32x32x16_bf16 v[128:143], v[64:67], v[80:83], v[128:143]
    ds_read_b64_tr_b16 v[96:97], v234 offset:16384
    ds_read_b64_tr_b16 v[98:99], v234 offset:17408
    v_mfma_f32_32x32x16_bf16 v[144:159], v[64:67], v[88:91], v[144:159]
    ds_read_b64_tr_b16 v[104:105], v235 offset:16384
    ds_read_b64_tr_b16 v[106:107], v235 offset:17408
    v_mfma_f32_32x32x16_bf16 v[160:175], v[72:75], v[80:83], v[160:175]
    ds_read_b128 v[112:115], v232 offset:16384
    ds_read_b128 v[120:123], v232 offset:20480
    v_mfma_f32_32x32x16_bf16 v[176:191], v[72:75], v[88:91], v[176:191]
    ds_read_b64_tr_b16 v[100:101], v234 offset:24576
    ds_read_b64_tr_b16 v[102:103], v234 offset:25600
    v_mfma_f32_32x32x16_bf16 v[128:143], v[68:71], v[84:87], v[128:143]
    ds_read_b64_tr_b16 v[108:109], v235 offset:24576
    ds_read_b64_tr_b16 v[110:111], v235 offset:25600
    v_mfma_f32_32x32x16_bf16 v[144:159], v[68:71], v[92:95], v[144:159]
    ds_read_b128 v[116:119], v233 offset:16384
    ds_read_b128 v[124:127], v233 offset:20480
    v_mfma_f32_32x32x16_bf16 v[160:175], v[76:79], v[84:87], v[160:175]
    v_mfma_f32_32x32x16_bf16 v[176:191], v[76:79], v[92:95], v[176:191]
    s_waitcnt lgkmcnt(0)
    s_barrier
    v_mfma_f32_32x32x16_bf16 v[128:143], v[96:99], v[112:115], v[128:143]
    ds_read_b64_tr_b16 v[64:65], v234 offset:32768
    ds_read_b64_tr_b16 v[66:67], v234 offset:33792
    v_mfma_f32_32x32x16_bf16 v[144:159], v[96:99], v[120:123], v[144:159]
    ds_read_b64_tr_b16 v[72:73], v235 offset:32768
    ds_read_b64_tr_b16 v[74:75], v235 offset:33792
    v_mfma_f32_32x32x16_bf16 v[160:175], v[104:107], v[112:115], v[160:175]
    ds_read_b128 v[80:83], v232 offset:32768
    ds_read_b128 v[88:91], v232 offset:36864
    v_mfma_f32_32x32x16_bf16 v[176:191], v[104:107], v[120:123], v[176:191]
    ds_read_b64_tr_b16 v[68:69], v234 offset:40960
    ds_read_b64_tr_b16 v[70:71], v234 offset:41984
    v_mfma_f32_32x32x16_bf16 v[128:143], v[100:103], v[116:119], v[128:143]
    ds_read_b64_tr_b16 v[76:77], v235 offset:40960
    ds_read_b64_tr_b16 v[78:79], v235 offset:41984
    v_mfma_f32_32x32x16_bf16 v[144:159], v[100:103], v[124:127], v[144:159]
    ds_read_b128 v[84:87], v233 offset:32768
    ds_read_b128 v[92:95], v233 offset:36864
    v_mfma_f32_32x32x16_bf16 v[160:175], v[108:111], v[116:119], v[160:175]
    v_mfma_f32_32x32x16_bf16 v[176:191], v[108:111], v[124:127], v[176:191]
    buffer_load_dword v50, v49, s[60:63], s6 offen
    buffer_load_dword v50, v49, s[60:63], s7 offen
    s_waitcnt lgkmcnt(0)
    s_barrier
    v_mfma_f32_32x32x16_bf16 v[128:143], v[64:67], v[80:83], v[128:143]
    ds_read_b64_tr_b16 v[96:97], v234 offset:49152
    ds_read_b64_tr_b16 v[98:99], v234 offset:50176
    v_mfma_f32_32x32x16_bf16 v[144:159], v[64:67], v[88:91], v[144:159]
    ds_read_b64_tr_b16 v[104:105], v235 offset:49152
    ds_read_b64_tr_b16 v[106:107], v235 offset:50176
    v_mfma_f32_32x32x16_bf16 v[160:175], v[72:75], v[80:83], v[160:175]
    ds_read_b128 v[112:115], v232 offset:49152
    ds_read_b128 v[120:123], v232 offset:53248
    v_mfma_f32_32x32x16_bf16 v[176:191], v[72:75], v[88:91], v[176:191]
    ds_read_b64_tr_b16 v[100:101], v234 offset:57344
    ds_read_b64_tr_b16 v[102:103], v234 offset:58368
    v_mfma_f32_32x32x16_bf16 v[128:143], v[68:71], v[84:87], v[128:143]
    ds_read_b64_tr_b16 v[108:109], v235 offset:57344
    ds_read_b64_tr_b16 v[110:111], v235 offset:58368
    v_mfma_f32_32x32x16_bf16 v[144:159], v[68:71], v[92:95], v[144:159]
    ds_read_b128 v[116:119], v233 offset:49152
    ds_read_b128 v[124:127], v233 offset:53248
    v_mfma_f32_32x32x16_bf16 v[160:175], v[76:79], v[84:87], v[160:175]
    v_mfma_f32_32x32x16_bf16 v[176:191], v[76:79], v[92:95], v[176:191]
    s_waitcnt lgkmcnt(0)
    s_barrier
    v_mfma_f32_32x32x16_bf16 v[128:143], v[96:99], v[112:115], v[128:143]
    ds_read_b64_tr_b16 v[64:65], v238 offset:0
    ds_read_b64_tr_b16 v[66:67], v238 offset:1024
    v_mfma_f32_32x32x16_bf16 v[144:159], v[96:99], v[120:123], v[144:159]
    ds_read_b64_tr_b16 v[72:73], v239 offset:0
    ds_read_b64_tr_b16 v[74:75], v239 offset:1024
    v_mfma_f32_32x32x16_bf16 v[160:175], v[104:107], v[112:115], v[160:175]
    ds_read_b128 v[80:83], v236 offset:0
    ds_read_b128 v[88:91], v236 offset:4096
    v_mfma_f32_32x32x16_bf16 v[176:191], v[104:107], v[120:123], v[176:191]
    ds_read_b64_tr_b16 v[68:69], v238 offset:8192
    ds_read_b64_tr_b16 v[70:71], v238 offset:9216
    v_mfma_f32_32x32x16_bf16 v[128:143], v[100:103], v[116:119], v[128:143]
    ds_read_b64_tr_b16 v[76:77], v239 offset:8192
    ds_read_b64_tr_b16 v[78:79], v239 offset:9216
    v_mfma_f32_32x32x16_bf16 v[144:159], v[100:103], v[124:127], v[144:159]
    ds_read_b128 v[84:87], v237 offset:0
    ds_read_b128 v[92:95], v237 offset:4096
    v_mfma_f32_32x32x16_bf16 v[160:175], v[108:111], v[116:119], v[160:175]
    v_mfma_f32_32x32x16_bf16 v[176:191], v[108:111], v[124:127], v[176:191]
    s_waitcnt lgkmcnt(0)
    s_barrier
    v_mfma_f32_32x32x16_bf16 v[128:143], v[64:67], v[80:83], v[128:143]
    ds_read_b64_tr_b16 v[96:97], v234 offset:0
    ds_read_b64_tr_b16 v[98:99], v234 offset:1024
    v_mfma_f32_32x32x16_bf16 v[144:159], v[64:67], v[88:91], v[144:159]
    ds_read_b64_tr_b16 v[104:105], v235 offset:0
    ds_read_b64_tr_b16 v[106:107], v235 offset:1024
    v_mfma_f32_32x32x16_bf16 v[160:175], v[72:75], v[80:83], v[160:175]
    ds_read_b128 v[112:115], v232 offset:0
    ds_read_b128 v[120:123], v232 offset:4096
    v_mfma_f32_32x32x16_bf16 v[176:191], v[72:75], v[88:91], v[176:191]
    ds_read_b64_tr_b16 v[100:101], v234 offset:8192
    ds_read_b64_tr_b16 v[102:103], v234 offset:9216
    v_mfma_f32_32x32x16_bf16 v[128:143], v[68:71], v[84:87], v[128:143]
    ds_read_b64_tr_b16 v[108:109], v235 offset:8192
    ds_read_b64_tr_b16 v[110:111], v235 offset:9216
    v_mfma_f32_32x32x16_bf16 v[144:159], v[68:71], v[92:95], v[144:159]
    ds_read_b128 v[116:119], v233 offset:0
    ds_read_b128 v[124:127], v233 offset:4096
    v_mfma_f32_32x32x16_bf16 v[160:175], v[76:79], v[84:87], v[160:175]
    v_mfma_f32_32x32x16_bf16 v[176:191], v[76:79], v[92:95], v[176:191]
    s_waitcnt lgkmcnt(0)
    s_barrier
    v_mfma_f32_32x32x16_bf16 v[128:143], v[96:99], v[112:115], v[128:143]
    v_mfma_f32_32x32x16_bf16 v[144:159], v[96:99], v[120:123], v[144:159]
    v_mfma_f32_32x32x16_bf16 v[160:175], v[104:107], v[112:115], v[160:175]
    v_mfma_f32_32x32x16_bf16 v[176:191], v[104:107], v[120:123], v[176:191]
    v_mfma_f32_32x32x16_bf16 v[128:143], v[100:103], v[116:119], v[128:143]
    v_mfma_f32_32x32x16_bf16 v[144:159], v[100:103], v[124:127], v[144:159]
    v_mfma_f32_32x32x16_bf16 v[160:175], v[108:111], v[116:119], v[160:175]
    v_mfma_f32_32x32x16_bf16 v[176:191], v[108:111], v[124:127], v[176:191]
    s_waitcnt vmcnt(0)
    v_lshrrev_b64 v[52:53], s5, v[52:53]
    v_and_b32 v52, 0xff, v52
    s_nop 0
    v_readfirstlane_b32 s100, v52
    s_nop 0
    s_cmp_eq_u32 s100, 16
    s_cselect_b32 s4, 1, 0
    s_lshl_b32 s73, s71, 2
    s_lshl_b32 s74, s87, 1
    s_add_u32 s73, s73, s74
    s_mul_i32 s73, s73, 112
    s_lshl_b32 s74, s72, 3
    s_add_u32 s73, s73, s74
    s_lshl_b32 s74, s86, 2
    s_add_u32 s73, s73, s74
    s_lshl_b32 s73, s73, 10
    s_add_u32 s73, s73, 0x500000
    s_add_u32 s74, s73, 114688
    v_lshlrev_b32 v14, 4, v0
    s_nop 1
    s_cmp_eq_u32 s4, 0
    s_cbranch_scc1 Lslow_27
    s_add_u32 m0, s98, 0
    s_nop 0
    buffer_load_dwordx4 v2, s[60:63], s90 offen lds
    buffer_load_dwordx4 v3, s[60:63], s90 offen offset:1024 lds
    s_add_u32 s90, s90, 16384
    s_cmp_eq_u32 s90, s92
    s_cselect_b32 s90, s91, s90
    s_add_u32 m0, s98, 2048
    s_nop 0
    s_nop 0
    buffer_load_dwordx4 v2, s[60:63], s90 offen lds
    buffer_load_dwordx4 v3, s[60:63], s90 offen offset:1024 lds
    s_add_u32 s90, s90, 16384
    s_cmp_eq_u32 s90, s92
    s_cselect_b32 s90, s91, s90
    v_max_f32 v128, 0, v128
    v_max_f32 v129, 0, v129
    v_max_f32 v130, 0, v130
    v_max_f32 v131, 0, v131
    v_max_f32 v132, 0, v132
    v_max_f32 v133, 0, v133
    v_max_f32 v134, 0, v134
    v_max_f32 v135, 0, v135
    v_pk_mul_f32 v[128:129], v[128:129], v[128:129]
    v_pk_mul_f32 v[130:131], v[130:131], v[130:131]
    v_pk_mul_f32 v[132:133], v[132:133], v[132:133]
    v_pk_mul_f32 v[134:135], v[134:135], v[134:135]
    v_cvt_pk_bf16_f32 v64, v128, v129
    v_cvt_pk_bf16_f32 v65, v130, v131
    v_cvt_pk_bf16_f32 v66, v132, v133
    v_cvt_pk_bf16_f32 v67, v134, v135
    buffer_store_dwordx4 v[64:67], v14, s[48:51], s73 offen offset:0
    s_add_u32 m0, s98, 4096
    s_nop 0
    s_nop 0
    buffer_load_dwordx4 v2, s[60:63], s90 offen lds
    buffer_load_dwordx4 v3, s[60:63], s90 offen offset:1024 lds
    s_add_u32 s90, s90, 16384
    s_cmp_eq_u32 s90, s92
    s_cselect_b32 s90, s91, s90
    v_max_f32 v136, 0, v136
    v_max_f32 v137, 0, v137
    v_max_f32 v138, 0, v138
    v_max_f32 v139, 0, v139
    v_max_f32 v140, 0, v140
    v_max_f32 v141, 0, v141
    v_max_f32 v142, 0, v142
    v_max_f32 v143, 0, v143
    v_pk_mul_f32 v[136:137], v[136:137], v[136:137]
    v_pk_mul_f32 v[138:139], v[138:139], v[138:139]
    v_pk_mul_f32 v[140:141], v[140:141], v[140:141]
    v_pk_mul_f32 v[142:143], v[142:143], v[142:143]
    v_cvt_pk_bf16_f32 v68, v136, v137
    v_cvt_pk_bf16_f32 v69, v138, v139
    v_cvt_pk_bf16_f32 v70, v140, v141
    v_cvt_pk_bf16_f32 v71, v142, v143
    buffer_store_dwordx4 v[68:71], v14, s[48:51], s73 offen offset:1024
    s_add_u32 m0, s98, 6144
    s_nop 0
    s_nop 0
    buffer_load_dwordx4 v2, s[60:63], s90 offen lds
    buffer_load_dwordx4 v3, s[60:63], s90 offen offset:1024 lds
    s_add_u32 s90, s90, 16384
    s_cmp_eq_u32 s90, s92
    s_cselect_b32 s90, s91, s90
    s_add_u32 m0, s98, 8192
    s_nop 0
    s_nop 0
    buffer_load_dwordx4 v2, s[60:63], s90 offen lds
    buffer_load_dwordx4 v3, s[60:63], s90 offen offset:1024 lds
    s_add_u32 s90, s90, 16384
    s_cmp_eq_u32 s90, s92
    s_cselect_b32 s90, s91, s90
    v_max_f32 v144, 0, v144
    v_max_f32 v145, 0, v145
    v_max_f32 v146, 0, v146
    v_max_f32 v147, 0, v147
    v_max_f32 v148, 0, v148
    v_max_f32 v149, 0, v149
    v_max_f32 v150, 0, v150
    v_max_f32 v151, 0, v151
    v_pk_mul_f32 v[144:145], v[144:145], v[144:145]
    v_pk_mul_f32 v[146:147], v[146:147], v[146:147]
    v_pk_mul_f32 v[148:149], v[148:149], v[148:149]
    v_pk_mul_f32 v[150:151], v[150:151], v[150:151]
    v_cvt_pk_bf16_f32 v72, v144, v145
    v_cvt_pk_bf16_f32 v73, v146, v147
    v_cvt_pk_bf16_f32 v74, v148, v149
    v_cvt_pk_bf16_f32 v75, v150, v151
    buffer_store_dwordx4 v[72:75], v14, s[48:51], s74 offen offset:0
    s_add_u32 m0, s98, 10240
    s_nop 0
    s_nop 0
    buffer_load_dwordx4 v2, s[60:63], s90 offen lds
    buffer_load_dwordx4 v3, s[60:63], s90 offen offset:1024 lds
    s_add_u32 s90, s90, 16384
    s_cmp_eq_u32 s90, s92
    s_cselect_b32 s90, s91, s90
    v_max_f32 v152, 0, v152
    v_max_f32 v153, 0, v153
    v_max_f32 v154, 0, v154
    v_max_f32 v155, 0, v155
    v_max_f32 v156, 0, v156
    v_max_f32 v157, 0, v157
    v_max_f32 v158, 0, v158
    v_max_f32 v159, 0, v159
    v_pk_mul_f32 v[152:153], v[152:153], v[152:153]
    v_pk_mul_f32 v[154:155], v[154:155], v[154:155]
    v_pk_mul_f32 v[156:157], v[156:157], v[156:157]
    v_pk_mul_f32 v[158:159], v[158:159], v[158:159]
    v_cvt_pk_bf16_f32 v76, v152, v153
    v_cvt_pk_bf16_f32 v77, v154, v155
    v_cvt_pk_bf16_f32 v78, v156, v157
    v_cvt_pk_bf16_f32 v79, v158, v159
    buffer_store_dwordx4 v[76:79], v14, s[48:51], s74 offen offset:1024
    s_add_u32 m0, s98, 12288
    s_nop 0
    s_nop 0
    buffer_load_dwordx4 v2, s[60:63], s90 offen lds
    buffer_load_dwordx4 v3, s[60:63], s90 offen offset:1024 lds
    s_add_u32 s90, s90, 16384
    s_cmp_eq_u32 s90, s92
    s_cselect_b32 s90, s91, s90
    s_add_u32 m0, s98, 14336
    s_nop 0
    s_nop 0
    buffer_load_dwordx4 v2, s[60:63], s90 offen lds
    buffer_load_dwordx4 v3, s[60:63], s90 offen offset:1024 lds
    s_add_u32 s90, s90, 16384
    s_cmp_eq_u32 s90, s92
    s_cselect_b32 s90, s91, s90
    v_max_f32 v160, 0, v160
    v_max_f32 v161, 0, v161
    v_max_f32 v162, 0, v162
    v_max_f32 v163, 0, v163
    v_max_f32 v164, 0, v164
    v_max_f32 v165, 0, v165
    v_max_f32 v166, 0, v166
    v_max_f32 v167, 0, v167
    v_pk_mul_f32 v[160:161], v[160:161], v[160:161]
    v_pk_mul_f32 v[162:163], v[162:163], v[162:163]
    v_pk_mul_f32 v[164:165], v[164:165], v[164:165]
    v_pk_mul_f32 v[166:167], v[166:167], v[166:167]
    v_cvt_pk_bf16_f32 v80, v160, v161
    v_cvt_pk_bf16_f32 v81, v162, v163
    v_cvt_pk_bf16_f32 v82, v164, v165
    v_cvt_pk_bf16_f32 v83, v166, v167
    buffer_store_dwordx4 v[80:83], v14, s[48:51], s73 offen offset:2048
    s_add_u32 m0, s98, 16384
    s_nop 0
    s_nop 0
    buffer_load_dwordx4 v2, s[60:63], s90 offen lds
    buffer_load_dwordx4 v3, s[60:63], s90 offen offset:1024 lds
    s_add_u32 s90, s90, 16384
    s_cmp_eq_u32 s90, s92
    s_cselect_b32 s90, s91, s90
    v_max_f32 v168, 0, v168
    v_max_f32 v169, 0, v169
    v_max_f32 v170, 0, v170
    v_max_f32 v171, 0, v171
    v_max_f32 v172, 0, v172
    v_max_f32 v173, 0, v173
    v_max_f32 v174, 0, v174
    v_max_f32 v175, 0, v175
    v_pk_mul_f32 v[168:169], v[168:169], v[168:169]
    v_pk_mul_f32 v[170:171], v[170:171], v[170:171]
    v_pk_mul_f32 v[172:173], v[172:173], v[172:173]
    v_pk_mul_f32 v[174:175], v[174:175], v[174:175]
    v_cvt_pk_bf16_f32 v84, v168, v169
    v_cvt_pk_bf16_f32 v85, v170, v171
    v_cvt_pk_bf16_f32 v86, v172, v173
    v_cvt_pk_bf16_f32 v87, v174, v175
    buffer_store_dwordx4 v[84:87], v14, s[48:51], s73 offen offset:3072
    s_add_u32 m0, s98, 18432
    s_nop 0
    s_nop 0
    buffer_load_dwordx4 v2, s[60:63], s90 offen lds
    buffer_load_dwordx4 v3, s[60:63], s90 offen offset:1024 lds
    s_add_u32 s90, s90, 16384
    s_cmp_eq_u32 s90, s92
    s_cselect_b32 s90, s91, s90
    v_max_f32 v176, 0, v176
    v_max_f32 v177, 0, v177
    v_max_f32 v178, 0, v178
    v_max_f32 v179, 0, v179
    v_max_f32 v180, 0, v180
    v_max_f32 v181, 0, v181
    v_max_f32 v182, 0, v182
    v_max_f32 v183, 0, v183
    v_pk_mul_f32 v[176:177], v[176:177], v[176:177]
    v_pk_mul_f32 v[178:179], v[178:179], v[178:179]
    v_pk_mul_f32 v[180:181], v[180:181], v[180:181]
    v_pk_mul_f32 v[182:183], v[182:183], v[182:183]
    v_cvt_pk_bf16_f32 v88, v176, v177
    v_cvt_pk_bf16_f32 v89, v178, v179
    v_cvt_pk_bf16_f32 v90, v180, v181
    v_cvt_pk_bf16_f32 v91, v182, v183
    buffer_store_dwordx4 v[88:91], v14, s[48:51], s74 offen offset:2048
    v_max_f32 v184, 0, v184
    v_max_f32 v185, 0, v185
    v_max_f32 v186, 0, v186
    v_max_f32 v187, 0, v187
    v_max_f32 v188, 0, v188
    v_max_f32 v189, 0, v189
    v_max_f32 v190, 0, v190
    v_max_f32 v191, 0, v191
    v_pk_mul_f32 v[184:185], v[184:185], v[184:185]
    v_pk_mul_f32 v[186:187], v[186:187], v[186:187]
    v_pk_mul_f32 v[188:189], v[188:189], v[188:189]
    v_pk_mul_f32 v[190:191], v[190:191], v[190:191]
    v_cvt_pk_bf16_f32 v92, v184, v185
    v_cvt_pk_bf16_f32 v93, v186, v187
    v_cvt_pk_bf16_f32 v94, v188, v189
    v_cvt_pk_bf16_f32 v95, v190, v191
    buffer_store_dwordx4 v[92:95], v14, s[48:51], s74 offen offset:3072
    s_waitcnt vmcnt(0)
    s_branch Lafter1_26
.p2align 3
Lslow_27:
    s_add_u32 m0, s98, 0
    s_nop 0
    buffer_load_dwordx4 v2, s[60:63], s90 offen lds
    buffer_load_dwordx4 v3, s[60:63], s90 offen offset:1024 lds
    s_add_u32 s90, s90, 16384
    s_cmp_eq_u32 s90, s92
    s_cselect_b32 s90, s91, s90
    s_add_u32 m0, s98, 2048
    s_nop 0
    s_nop 0
    buffer_load_dwordx4 v2, s[60:63], s90 offen lds
    buffer_load_dwordx4 v3, s[60:63], s90 offen offset:1024 lds
    s_add_u32 s90, s90, 16384
    s_cmp_eq_u32 s90, s92
    s_cselect_b32 s90, s91, s90
    v_max_f32 v128, 0, v128
    v_max_f32 v129, 0, v129
    v_max_f32 v130, 0, v130
    v_max_f32 v131, 0, v131
    v_max_f32 v132, 0, v132
    v_max_f32 v133, 0, v133
    v_max_f32 v134, 0, v134
    v_max_f32 v135, 0, v135
    v_pk_mul_f32 v[128:129], v[128:129], v[128:129]
    v_pk_mul_f32 v[130:131], v[130:131], v[130:131]
    v_pk_mul_f32 v[132:133], v[132:133], v[132:133]
    v_pk_mul_f32 v[134:135], v[134:135], v[134:135]
    v_cvt_pk_bf16_f32 v64, v128, v129
    v_cvt_pk_bf16_f32 v65, v130, v131
    v_cvt_pk_bf16_f32 v66, v132, v133
    v_cvt_pk_bf16_f32 v67, v134, v135
    buffer_store_dwordx4 v[64:67], v14, s[48:51], s73 offen offset:0 sc1
    s_add_u32 m0, s98, 4096
    s_nop 0
    s_nop 0
    buffer_load_dwordx4 v2, s[60:63], s90 offen lds
    buffer_load_dwordx4 v3, s[60:63], s90 offen offset:1024 lds
    s_add_u32 s90, s90, 16384
    s_cmp_eq_u32 s90, s92
    s_cselect_b32 s90, s91, s90
    v_max_f32 v136, 0, v136
    v_max_f32 v137, 0, v137
    v_max_f32 v138, 0, v138
    v_max_f32 v139, 0, v139
    v_max_f32 v140, 0, v140
    v_max_f32 v141, 0, v141
    v_max_f32 v142, 0, v142
    v_max_f32 v143, 0, v143
    v_pk_mul_f32 v[136:137], v[136:137], v[136:137]
    v_pk_mul_f32 v[138:139], v[138:139], v[138:139]
    v_pk_mul_f32 v[140:141], v[140:141], v[140:141]
    v_pk_mul_f32 v[142:143], v[142:143], v[142:143]
    v_cvt_pk_bf16_f32 v68, v136, v137
    v_cvt_pk_bf16_f32 v69, v138, v139
    v_cvt_pk_bf16_f32 v70, v140, v141
    v_cvt_pk_bf16_f32 v71, v142, v143
    buffer_store_dwordx4 v[68:71], v14, s[48:51], s73 offen offset:1024 sc1
    s_add_u32 m0, s98, 6144
    s_nop 0
    s_nop 0
    buffer_load_dwordx4 v2, s[60:63], s90 offen lds
    buffer_load_dwordx4 v3, s[60:63], s90 offen offset:1024 lds
    s_add_u32 s90, s90, 16384
    s_cmp_eq_u32 s90, s92
    s_cselect_b32 s90, s91, s90
    s_add_u32 m0, s98, 8192
    s_nop 0
    s_nop 0
    buffer_load_dwordx4 v2, s[60:63], s90 offen lds
    buffer_load_dwordx4 v3, s[60:63], s90 offen offset:1024 lds
    s_add_u32 s90, s90, 16384
    s_cmp_eq_u32 s90, s92
    s_cselect_b32 s90, s91, s90
    v_max_f32 v144, 0, v144
    v_max_f32 v145, 0, v145
    v_max_f32 v146, 0, v146
    v_max_f32 v147, 0, v147
    v_max_f32 v148, 0, v148
    v_max_f32 v149, 0, v149
    v_max_f32 v150, 0, v150
    v_max_f32 v151, 0, v151
    v_pk_mul_f32 v[144:145], v[144:145], v[144:145]
    v_pk_mul_f32 v[146:147], v[146:147], v[146:147]
    v_pk_mul_f32 v[148:149], v[148:149], v[148:149]
    v_pk_mul_f32 v[150:151], v[150:151], v[150:151]
    v_cvt_pk_bf16_f32 v72, v144, v145
    v_cvt_pk_bf16_f32 v73, v146, v147
    v_cvt_pk_bf16_f32 v74, v148, v149
    v_cvt_pk_bf16_f32 v75, v150, v151
    buffer_store_dwordx4 v[72:75], v14, s[48:51], s74 offen offset:0 sc1
    s_add_u32 m0, s98, 10240
    s_nop 0
    s_nop 0
    buffer_load_dwordx4 v2, s[60:63], s90 offen lds
    buffer_load_dwordx4 v3, s[60:63], s90 offen offset:1024 lds
    s_add_u32 s90, s90, 16384
    s_cmp_eq_u32 s90, s92
    s_cselect_b32 s90, s91, s90
    v_max_f32 v152, 0, v152
    v_max_f32 v153, 0, v153
    v_max_f32 v154, 0, v154
    v_max_f32 v155, 0, v155
    v_max_f32 v156, 0, v156
    v_max_f32 v157, 0, v157
    v_max_f32 v158, 0, v158
    v_max_f32 v159, 0, v159
    v_pk_mul_f32 v[152:153], v[152:153], v[152:153]
    v_pk_mul_f32 v[154:155], v[154:155], v[154:155]
    v_pk_mul_f32 v[156:157], v[156:157], v[156:157]
    v_pk_mul_f32 v[158:159], v[158:159], v[158:159]
    v_cvt_pk_bf16_f32 v76, v152, v153
    v_cvt_pk_bf16_f32 v77, v154, v155
    v_cvt_pk_bf16_f32 v78, v156, v157
    v_cvt_pk_bf16_f32 v79, v158, v159
    buffer_store_dwordx4 v[76:79], v14, s[48:51], s74 offen offset:1024 sc1
    s_add_u32 m0, s98, 12288
    s_nop 0
    s_nop 0
    buffer_load_dwordx4 v2, s[60:63], s90 offen lds
    buffer_load_dwordx4 v3, s[60:63], s90 offen offset:1024 lds
    s_add_u32 s90, s90, 16384
    s_cmp_eq_u32 s90, s92
    s_cselect_b32 s90, s91, s90
    s_add_u32 m0, s98, 14336
    s_nop 0
    s_nop 0
    buffer_load_dwordx4 v2, s[60:63], s90 offen lds
    buffer_load_dwordx4 v3, s[60:63], s90 offen offset:1024 lds
    s_add_u32 s90, s90, 16384
    s_cmp_eq_u32 s90, s92
    s_cselect_b32 s90, s91, s90
    v_max_f32 v160, 0, v160
    v_max_f32 v161, 0, v161
    v_max_f32 v162, 0, v162
    v_max_f32 v163, 0, v163
    v_max_f32 v164, 0, v164
    v_max_f32 v165, 0, v165
    v_max_f32 v166, 0, v166
    v_max_f32 v167, 0, v167
    v_pk_mul_f32 v[160:161], v[160:161], v[160:161]
    v_pk_mul_f32 v[162:163], v[162:163], v[162:163]
    v_pk_mul_f32 v[164:165], v[164:165], v[164:165]
    v_pk_mul_f32 v[166:167], v[166:167], v[166:167]
    v_cvt_pk_bf16_f32 v80, v160, v161
    v_cvt_pk_bf16_f32 v81, v162, v163
    v_cvt_pk_bf16_f32 v82, v164, v165
    v_cvt_pk_bf16_f32 v83, v166, v167
    buffer_store_dwordx4 v[80:83], v14, s[48:51], s73 offen offset:2048 sc1
    s_add_u32 m0, s98, 16384
    s_nop 0
    s_nop 0
    buffer_load_dwordx4 v2, s[60:63], s90 offen lds
    buffer_load_dwordx4 v3, s[60:63], s90 offen offset:1024 lds
    s_add_u32 s90, s90, 16384
    s_cmp_eq_u32 s90, s92
    s_cselect_b32 s90, s91, s90
    v_max_f32 v168, 0, v168
    v_max_f32 v169, 0, v169
    v_max_f32 v170, 0, v170
    v_max_f32 v171, 0, v171
    v_max_f32 v172, 0, v172
    v_max_f32 v173, 0, v173
    v_max_f32 v174, 0, v174
    v_max_f32 v175, 0, v175
    v_pk_mul_f32 v[168:169], v[168:169], v[168:169]
    v_pk_mul_f32 v[170:171], v[170:171], v[170:171]
    v_pk_mul_f32 v[172:173], v[172:173], v[172:173]
    v_pk_mul_f32 v[174:175], v[174:175], v[174:175]
    v_cvt_pk_bf16_f32 v84, v168, v169
    v_cvt_pk_bf16_f32 v85, v170, v171
    v_cvt_pk_bf16_f32 v86, v172, v173
    v_cvt_pk_bf16_f32 v87, v174, v175
    buffer_store_dwordx4 v[84:87], v14, s[48:51], s73 offen offset:3072 sc1
    s_add_u32 m0, s98, 18432
    s_nop 0
    s_nop 0
    buffer_load_dwordx4 v2, s[60:63], s90 offen lds
    buffer_load_dwordx4 v3, s[60:63], s90 offen offset:1024 lds
    s_add_u32 s90, s90, 16384
    s_cmp_eq_u32 s90, s92
    s_cselect_b32 s90, s91, s90
    v_max_f32 v176, 0, v176
    v_max_f32 v177, 0, v177
    v_max_f32 v178, 0, v178
    v_max_f32 v179, 0, v179
    v_max_f32 v180, 0, v180
    v_max_f32 v181, 0, v181
    v_max_f32 v182, 0, v182
    v_max_f32 v183, 0, v183
    v_pk_mul_f32 v[176:177], v[176:177], v[176:177]
    v_pk_mul_f32 v[178:179], v[178:179], v[178:179]
    v_pk_mul_f32 v[180:181], v[180:181], v[180:181]
    v_pk_mul_f32 v[182:183], v[182:183], v[182:183]
    v_cvt_pk_bf16_f32 v88, v176, v177
    v_cvt_pk_bf16_f32 v89, v178, v179
    v_cvt_pk_bf16_f32 v90, v180, v181
    v_cvt_pk_bf16_f32 v91, v182, v183
    buffer_store_dwordx4 v[88:91], v14, s[48:51], s74 offen offset:2048 sc1
    v_max_f32 v184, 0, v184
    v_max_f32 v185, 0, v185
    v_max_f32 v186, 0, v186
    v_max_f32 v187, 0, v187
    v_max_f32 v188, 0, v188
    v_max_f32 v189, 0, v189
    v_max_f32 v190, 0, v190
    v_max_f32 v191, 0, v191
    v_pk_mul_f32 v[184:185], v[184:185], v[184:185]
    v_pk_mul_f32 v[186:187], v[186:187], v[186:187]
    v_pk_mul_f32 v[188:189], v[188:189], v[188:189]
    v_pk_mul_f32 v[190:191], v[190:191], v[190:191]
    v_cvt_pk_bf16_f32 v92, v184, v185
    v_cvt_pk_bf16_f32 v93, v186, v187
    v_cvt_pk_bf16_f32 v94, v188, v189
    v_cvt_pk_bf16_f32 v95, v190, v191
    buffer_store_dwordx4 v[92:95], v14, s[48:51], s74 offen offset:3072 sc1
    s_waitcnt vmcnt(0)
    s_branch Lafter1_26
.p2align 3
Lgate_25:
    s_lshl_b32 s73, s71, 7
    s_sub_u32 s74, s72, 14
    s_lshl_b32 s74, s74, 6
    s_add_u32 s73, s73, s74
    s_lshl_b32 s74, s96, 4
    s_add_u32 s73, s73, s74
    s_lshl_b32 s74, s73, 10
    v_lshlrev_b32 v14, 4, v0
    global_load_dwordx4 v[16:19], v14, s[36:37]
    buffer_load_dwordx4 v[64:67], v14, s[44:47], s74 offen offset:0
    buffer_load_dwordx4 v[68:71], v14, s[44:47], s74 offen offset:1024
    buffer_load_dwordx4 v[72:75], v14, s[44:47], s74 offen offset:2048
    buffer_load_dwordx4 v[76:79], v14, s[44:47], s74 offen offset:3072
    s_add_u32 s74, s74, 4096
    buffer_load_dwordx4 v[80:83], v14, s[44:47], s74 offen offset:0
    buffer_load_dwordx4 v[84:87], v14, s[44:47], s74 offen offset:1024
    buffer_load_dwordx4 v[88:91], v14, s[44:47], s74 offen offset:2048
    buffer_load_dwordx4 v[92:95], v14, s[44:47], s74 offen offset:3072
    s_add_u32 s74, s74, 4096
    buffer_load_dwordx4 v[96:99], v14, s[44:47], s74 offen offset:0
    buffer_load_dwordx4 v[100:103], v14, s[44:47], s74 offen offset:1024
    buffer_load_dwordx4 v[104:107], v14, s[44:47], s74 offen offset:2048
    buffer_load_dwordx4 v[108:111], v14, s[44:47], s74 offen offset:3072
    s_add_u32 s74, s74, 4096
    buffer_load_dwordx4 v[112:115], v14, s[44:47], s74 offen offset:0
    buffer_load_dwordx4 v[116:119], v14, s[44:47], s74 offen offset:1024
    buffer_load_dwordx4 v[120:123], v14, s[44:47], s74 offen offset:2048
    buffer_load_dwordx4 v[124:127], v14, s[44:47], s74 offen offset:3072
    s_waitcnt vmcnt(15)
    v_mov_b32 v32, 0
    v_dot2_f32_bf16 v32, v64, v16, v32
    v_dot2_f32_bf16 v32, v65, v17, v32
    v_dot2_f32_bf16 v32, v66, v18, v32
    v_dot2_f32_bf16 v32, v67, v19, v32
    s_waitcnt vmcnt(14)
    v_mov_b32 v33, 0
    v_dot2_f32_bf16 v33, v68, v16, v33
    v_dot2_f32_bf16 v33, v69, v17, v33
    v_dot2_f32_bf16 v33, v70, v18, v33
    v_dot2_f32_bf16 v33, v71, v19, v33
    s_waitcnt vmcnt(13)
    v_mov_b32 v34, 0
    v_dot2_f32_bf16 v34, v72, v16, v34
    v_dot2_f32_bf16 v34, v73, v17, v34
    v_dot2_f32_bf16 v34, v74, v18, v34
    v_dot2_f32_bf16 v34, v75, v19, v34
    s_waitcnt vmcnt(12)
    v_mov_b32 v35, 0
    v_dot2_f32_bf16 v35, v76, v16, v35
    v_dot2_f32_bf16 v35, v77, v17, v35
    v_dot2_f32_bf16 v35, v78, v18, v35
    v_dot2_f32_bf16 v35, v79, v19, v35
    s_waitcnt vmcnt(11)
    v_mov_b32 v36, 0
    v_dot2_f32_bf16 v36, v80, v16, v36
    v_dot2_f32_bf16 v36, v81, v17, v36
    v_dot2_f32_bf16 v36, v82, v18, v36
    v_dot2_f32_bf16 v36, v83, v19, v36
    s_waitcnt vmcnt(10)
    v_mov_b32 v37, 0
    v_dot2_f32_bf16 v37, v84, v16, v37
    v_dot2_f32_bf16 v37, v85, v17, v37
    v_dot2_f32_bf16 v37, v86, v18, v37
    v_dot2_f32_bf16 v37, v87, v19, v37
    s_waitcnt vmcnt(9)
    v_mov_b32 v38, 0
    v_dot2_f32_bf16 v38, v88, v16, v38
    v_dot2_f32_bf16 v38, v89, v17, v38
    v_dot2_f32_bf16 v38, v90, v18, v38
    v_dot2_f32_bf16 v38, v91, v19, v38
    s_waitcnt vmcnt(8)
    v_mov_b32 v39, 0
    v_dot2_f32_bf16 v39, v92, v16, v39
    v_dot2_f32_bf16 v39, v93, v17, v39
    v_dot2_f32_bf16 v39, v94, v18, v39
    v_dot2_f32_bf16 v39, v95, v19, v39
    s_waitcnt vmcnt(7)
    v_mov_b32 v40, 0
    v_dot2_f32_bf16 v40, v96, v16, v40
    v_dot2_f32_bf16 v40, v97, v17, v40
    v_dot2_f32_bf16 v40, v98, v18, v40
    v_dot2_f32_bf16 v40, v99, v19, v40
    s_waitcnt vmcnt(6)
    v_mov_b32 v41, 0
    v_dot2_f32_bf16 v41, v100, v16, v41
    v_dot2_f32_bf16 v41, v101, v17, v41
    v_dot2_f32_bf16 v41, v102, v18, v41
    v_dot2_f32_bf16 v41, v103, v19, v41
    s_waitcnt vmcnt(5)
    v_mov_b32 v42, 0
    v_dot2_f32_bf16 v42, v104, v16, v42
    v_dot2_f32_bf16 v42, v105, v17, v42
    v_dot2_f32_bf16 v42, v106, v18, v42
    v_dot2_f32_bf16 v42, v107, v19, v42
    s_waitcnt vmcnt(4)
    v_mov_b32 v43, 0
    v_dot2_f32_bf16 v43, v108, v16, v43
    v_dot2_f32_bf16 v43, v109, v17, v43
    v_dot2_f32_bf16 v43, v110, v18, v43
    v_dot2_f32_bf16 v43, v111, v19, v43
    s_waitcnt vmcnt(3)
    v_mov_b32 v44, 0
    v_dot2_f32_bf16 v44, v112, v16, v44
    v_dot2_f32_bf16 v44, v113, v17, v44
    v_dot2_f32_bf16 v44, v114, v18, v44
    v_dot2_f32_bf16 v44, v115, v19, v44
    s_waitcnt vmcnt(2)
    v_mov_b32 v45, 0
    v_dot2_f32_bf16 v45, v116, v16, v45
    v_dot2_f32_bf16 v45, v117, v17, v45
    v_dot2_f32_bf16 v45, v118, v18, v45
    v_dot2_f32_bf16 v45, v119, v19, v45
    s_waitcnt vmcnt(1)
    v_mov_b32 v46, 0
    v_dot2_f32_bf16 v46, v120, v16, v46
    v_dot2_f32_bf16 v46, v121, v17, v46
    v_dot2_f32_bf16 v46, v122, v18, v46
    v_dot2_f32_bf16 v46, v123, v19, v46
    s_waitcnt vmcnt(0)
    v_mov_b32 v47, 0
    v_dot2_f32_bf16 v47, v124, v16, v47
    v_dot2_f32_bf16 v47, v125, v17, v47
    v_dot2_f32_bf16 v47, v126, v18, v47
    v_dot2_f32_bf16 v47, v127, v19, v47
    s_nop 2
    v_permlane32_swap_b32 v32, v40
    v_permlane32_swap_b32 v33, v41
    v_permlane32_swap_b32 v34, v42
    v_permlane32_swap_b32 v35, v43
    v_permlane32_swap_b32 v36, v44
    v_permlane32_swap_b32 v37, v45
    v_permlane32_swap_b32 v38, v46
    v_permlane32_swap_b32 v39, v47
    s_nop 1
    v_add_f32 v32, v32, v40
    v_add_f32 v33, v33, v41
    v_add_f32 v34, v34, v42
    v_add_f32 v35, v35, v43
    v_add_f32 v36, v36, v44
    v_add_f32 v37, v37, v45
    v_add_f32 v38, v38, v46
    v_add_f32 v39, v39, v47
    s_nop 1
    v_permlane16_swap_b32 v32, v36
    v_permlane16_swap_b32 v33, v37
    v_permlane16_swap_b32 v34, v38
    v_permlane16_swap_b32 v35, v39
    s_nop 1
    v_add_f32 v32, v32, v36
    v_add_f32 v33, v33, v37
    v_add_f32 v34, v34, v38
    v_add_f32_e64 v35, v35, v39
    s_nop 1
    v_add_f32_dpp v32, v32, v32 row_ror:8 row_mask:0xf bank_mask:0xf
    v_add_f32_dpp v33, v33, v33 row_ror:8 row_mask:0xf bank_mask:0xf
    v_add_f32_dpp v34, v34, v34 row_ror:8 row_mask:0xf bank_mask:0xf
    v_add_f32_dpp v35, v35, v35 row_ror:8 row_mask:0xf bank_mask:0xf
    s_nop 1
    s_nop 0
    v_add_f32_dpp v32, v32, v32 row_ror:4 row_mask:0xf bank_mask:0xf
    v_add_f32_dpp v33, v33, v33 row_ror:4 row_mask:0xf bank_mask:0xf
    v_add_f32_dpp v34, v34, v34 row_ror:4 row_mask:0xf bank_mask:0xf
    v_add_f32_dpp v35, v35, v35 row_ror:4 row_mask:0xf bank_mask:0xf
    s_nop 1
    s_nop 0
    v_add_f32_dpp v32, v32, v32 row_ror:2 row_mask:0xf bank_mask:0xf
    v_add_f32_dpp v33, v33, v33 row_ror:2 row_mask:0xf bank_mask:0xf
    v_add_f32_dpp v34, v34, v34 row_ror:2 row_mask:0xf bank_mask:0xf
    v_add_f32_dpp v35, v35, v35 row_ror:2 row_mask:0xf bank_mask:0xf
    s_nop 1
    s_nop 0
    v_add_f32_dpp v32, v32, v32 row_ror:1 row_mask:0xf bank_mask:0xf
    v_add_f32_dpp v33, v33, v33 row_ror:1 row_mask:0xf bank_mask:0xf
    v_add_f32_dpp v34, v34, v34 row_ror:1 row_mask:0xf bank_mask:0xf
    v_add_f32_dpp v35, v35, v35 row_ror:1 row_mask:0xf bank_mask:0xf
    v_and_b32 v15, 3, v0
    v_cmp_eq_u32 vcc, 1, v15
    s_nop 1
    v_cndmask_b32 v32, v32, v33, vcc
    v_cmp_eq_u32 vcc, 2, v15
    s_nop 1
    v_cndmask_b32 v32, v32, v34, vcc
    v_cmp_eq_u32 vcc, 3, v15
    s_nop 1
    v_cndmask_b32 v32, v32, v35, vcc
    s_mov_b32 s74, 0x3fb8aa3b
    v_cvt_pk_bf16_f32 v32, v32, v32
    v_and_b32 v32, 0xffff0000, v32
    v_mul_f32_e64 v32, s74, v32
    v_exp_f32 v32, -v32
    s_nop 0
    v_add_f32 v32, 1.0, v32
    v_rcp_f32 v32, v32
    s_nop 0
    v_cvt_pk_bf16_f32 v32, v32, v32
    v_and_b32 v32, 0xffff0000, v32
    v_lshrrev_b32_e64 v14, 4, v0
    v_lshl_add_u32 v14, v14, 2, v15
    v_lshlrev_b32 v14, 2, v14
    s_lshl_b32 s73, s73, 2
    s_add_u32 s73, s73, 0x400000
    v_and_b32 v15, 12, v0
    v_cmp_eq_u32 vcc, 0, v15
    s_nop 1
    s_and_b64 exec, exec, vcc
    buffer_store_dword v32, v14, s[48:51], s73 offen sc1
    s_mov_b64 exec, -1
    s_mov_b32 s4, 0
    buffer_load_dword v50, v49, s[60:63], s6 offen
    buffer_load_dword v50, v49, s[60:63], s7 offen
    s_barrier
    s_barrier
    s_barrier
    s_barrier
    s_barrier
    s_barrier
    s_barrier
    s_barrier
    s_barrier
    s_barrier
    s_barrier
    s_barrier
    s_barrier
    s_barrier
    s_barrier
    s_barrier
    s_barrier
    s_waitcnt vmcnt(0)
    s_add_u32 m0, s98, 0
    s_nop 0
    buffer_load_dwordx4 v2, s[60:63], s90 offen lds
    buffer_load_dwordx4 v3, s[60:63], s90 offen offset:1024 lds
    s_add_u32 s90, s90, 16384
    s_cmp_eq_u32 s90, s92
    s_cselect_b32 s90, s91, s90
    s_add_u32 m0, s98, 2048
    s_nop 0
    s_nop 0
    buffer_load_dwordx4 v2, s[60:63], s90 offen lds
    buffer_load_dwordx4 v3, s[60:63], s90 offen offset:1024 lds
    s_add_u32 s90, s90, 16384
    s_cmp_eq_u32 s90, s92
    s_cselect_b32 s90, s91, s90
    s_add_u32 m0, s98, 4096
    s_nop 0
    s_nop 0
    buffer_load_dwordx4 v2, s[60:63], s90 offen lds
    buffer_load_dwordx4 v3, s[60:63], s90 offen offset:1024 lds
    s_add_u32 s90, s90, 16384
    s_cmp_eq_u32 s90, s92
    s_cselect_b32 s90, s91, s90
    s_add_u32 m0, s98, 6144
    s_nop 0
    s_nop 0
    buffer_load_dwordx4 v2, s[60:63], s90 offen lds
    buffer_load_dwordx4 v3, s[60:63], s90 offen offset:1024 lds
    s_add_u32 s90, s90, 16384
    s_cmp_eq_u32 s90, s92
    s_cselect_b32 s90, s91, s90
    s_add_u32 m0, s98, 8192
    s_nop 0
    s_nop 0
    buffer_load_dwordx4 v2, s[60:63], s90 offen lds
    buffer_load_dwordx4 v3, s[60:63], s90 offen offset:1024 lds
    s_add_u32 s90, s90, 16384
    s_cmp_eq_u32 s90, s92
    s_cselect_b32 s90, s91, s90
    s_add_u32 m0, s98, 10240
    s_nop 0
    s_nop 0
    buffer_load_dwordx4 v2, s[60:63], s90 offen lds
    buffer_load_dwordx4 v3, s[60:63], s90 offen offset:1024 lds
    s_add_u32 s90, s90, 16384
    s_cmp_eq_u32 s90, s92
    s_cselect_b32 s90, s91, s90
    s_add_u32 m0, s98, 12288
    s_nop 0
    s_nop 0
    buffer_load_dwordx4 v2, s[60:63], s90 offen lds
    buffer_load_dwordx4 v3, s[60:63], s90 offen offset:1024 lds
    s_add_u32 s90, s90, 16384
    s_cmp_eq_u32 s90, s92
    s_cselect_b32 s90, s91, s90
    s_add_u32 m0, s98, 14336
    s_nop 0
    s_nop 0
    buffer_load_dwordx4 v2, s[60:63], s90 offen lds
    buffer_load_dwordx4 v3, s[60:63], s90 offen offset:1024 lds
    s_add_u32 s90, s90, 16384
    s_cmp_eq_u32 s90, s92
    s_cselect_b32 s90, s91, s90
    s_add_u32 m0, s98, 16384
    s_nop 0
    s_nop 0
    buffer_load_dwordx4 v2, s[60:63], s90 offen lds
    buffer_load_dwordx4 v3, s[60:63], s90 offen offset:1024 lds
    s_add_u32 s90, s90, 16384
    s_cmp_eq_u32 s90, s92
    s_cselect_b32 s90, s91, s90
    s_add_u32 m0, s98, 18432
    s_nop 0
    s_nop 0
    buffer_load_dwordx4 v2, s[60:63], s90 offen lds
    buffer_load_dwordx4 v3, s[60:63], s90 offen offset:1024 lds
    s_add_u32 s90, s90, 16384
    s_cmp_eq_u32 s90, s92
    s_cselect_b32 s90, s91, s90
    s_waitcnt vmcnt(0)
.p2align 3
Lafter1_26:
    v_mov_b32 v14, 159840
    ds_read_b32 v15, v14
    s_waitcnt lgkmcnt(0)
    v_readfirstlane_b32 s99, v15
    v_mov_b32 v14, 159744
    v_mov_b32 v15, 1
    s_mov_b64 exec, 1
    ds_add_rtn_u32 v15, v14, v15
    s_waitcnt lgkmcnt(0)
    s_mov_b64 exec, -1
    v_readfirstlane_b32 s100, v15
    s_nop 0
    s_cmp_lg_u32 s100, 3
    s_cbranch_scc1 Lcp_28
    v_mov_b32 v250, s99
    v_mov_b32_e64 v251, 0
    s_mov_b64 exec, 1
    s_cmp_eq_u32 s4, 0
    s_cbranch_scc1 Lcf_29
    buffer_store_dword v250, v251, s[48:51], s84 offen
    s_branch Lcf_30
Lcf_29:
    buffer_store_dword v250, v251, s[48:51], s84 offen sc1
Lcf_30:
    s_mov_b64 exec, -1
Lcp_28:
    v_and_b32 v248, 15, v0
    v_lshlrev_b32_e64 v248, 7, v248
    s_waitcnt vmcnt(18)
    ds_read_b64_tr_b16 v[16:17], v6 offset:0
    ds_read_b64_tr_b16 v[18:19], v6 offset:512
    ds_read_b64_tr_b16 v[20:21], v7 offset:0
    ds_read_b64_tr_b16 v[22:23], v7 offset:512
    s_waitcnt vmcnt(16)
    s_nop 0
    ds_read_b64_tr_b16 v[24:25], v6 offset:2048
    ds_read_b64_tr_b16 v[26:27], v6 offset:2560
    ds_read_b64_tr_b16 v[28:29], v7 offset:2048
    ds_read_b64_tr_b16 v[30:31], v7 offset:2560
    s_waitcnt lgkmcnt(4)
    s_add_u32 m0, s98, 0
    s_nop 0
    s_nop 0
    buffer_load_dwordx4 v2, s[60:63], s90 offen lds
    buffer_load_dwordx4 v3, s[60:63], s90 offen offset:1024 lds
    s_add_u32 s90, s90, 16384
    s_cmp_eq_u32 s90, s92
    s_cselect_b32 s90, s91, s90
    s_waitcnt vmcnt(16)
    s_nop 0
    ds_read_b64_tr_b16 v[32:33], v6 offset:4096
    ds_read_b64_tr_b16 v[34:35], v6 offset:4608
    ds_read_b64_tr_b16 v[36:37], v7 offset:4096
    ds_read_b64_tr_b16 v[38:39], v7 offset:4608
    s_waitcnt lgkmcnt(4)
    s_add_u32 m0, s98, 2048
    s_nop 0
    buffer_load_dwordx4 v2, s[60:63], s90 offen lds
    buffer_load_dwordx4 v3, s[60:63], s90 offen offset:1024 lds
    s_add_u32 s90, s90, 16384
    s_cmp_eq_u32 s90, s92
    s_cselect_b32 s90, s91, s90
    s_waitcnt vmcnt(16)
    s_nop 0
    ds_read_b64_tr_b16 v[40:41], v6 offset:6144
    ds_read_b64_tr_b16 v[42:43], v6 offset:6656
    ds_read_b64_tr_b16 v[44:45], v7 offset:6144
    ds_read_b64_tr_b16 v[46:47], v7 offset:6656
    s_waitcnt lgkmcnt(4)
    s_add_u32 m0, s98, 4096
    s_nop 0
    buffer_load_dwordx4 v2, s[60:63], s90 offen lds
    buffer_load_dwordx4 v3, s[60:63], s90 offen offset:1024 lds
    s_add_u32 s90, s90, 16384
    s_cmp_eq_u32 s90, s92
    s_cselect_b32 s90, s91, s90
    s_waitcnt vmcnt(16)
    s_nop 0
    ds_read_b64_tr_b16 v[48:49], v6 offset:8192
    ds_read_b64_tr_b16 v[50:51], v6 offset:8704
    ds_read_b64_tr_b16 v[52:53], v7 offset:8192
    ds_read_b64_tr_b16 v[54:55], v7 offset:8704
    s_waitcnt lgkmcnt(4)
    s_add_u32 m0, s98, 6144
    s_nop 0
    buffer_load_dwordx4 v2, s[60:63], s90 offen lds
    buffer_load_dwordx4 v3, s[60:63], s90 offen offset:1024 lds
    s_add_u32 s90, s90, 16384
    s_cmp_eq_u32 s90, s92
    s_cselect_b32 s90, s91, s90
    s_waitcnt vmcnt(16)
    s_nop 0
    ds_read_b64_tr_b16 v[56:57], v6 offset:10240
    ds_read_b64_tr_b16 v[58:59], v6 offset:10752
    ds_read_b64_tr_b16 v[60:61], v7 offset:10240
    ds_read_b64_tr_b16 v[62:63], v7 offset:10752
    s_waitcnt lgkmcnt(4)
    s_add_u32 m0, s98, 8192
    s_nop 0
    buffer_load_dwordx4 v2, s[60:63], s90 offen lds
    buffer_load_dwordx4 v3, s[60:63], s90 offen offset:1024 lds
    s_add_u32 s90, s90, 16384
    s_cmp_eq_u32 s90, s92
    s_cselect_b32 s90, s91, s90
    s_waitcnt vmcnt(16)
    s_nop 0
    ds_read_b64_tr_b16 v[64:65], v6 offset:12288
    ds_read_b64_tr_b16 v[66:67], v6 offset:12800
    ds_read_b64_tr_b16 v[68:69], v7 offset:12288
    ds_read_b64_tr_b16 v[70:71], v7 offset:12800
    s_waitcnt lgkmcnt(4)
    s_add_u32 m0, s98, 10240
    s_nop 0
    buffer_load_dwordx4 v2, s[60:63], s90 offen lds
    buffer_load_dwordx4 v3, s[60:63], s90 offen offset:1024 lds
    s_add_u32 s90, s90, 16384
    s_cmp_eq_u32 s90, s92
    s_cselect_b32 s90, s91, s90
    s_waitcnt vmcnt(16)
    s_nop 0
    ds_read_b64_tr_b16 v[72:73], v6 offset:14336
    ds_read_b64_tr_b16 v[74:75], v6 offset:14848
    ds_read_b64_tr_b16 v[76:77], v7 offset:14336
    ds_read_b64_tr_b16 v[78:79], v7 offset:14848
    s_waitcnt lgkmcnt(4)
    s_add_u32 m0, s98, 12288
    s_nop 0
    buffer_load_dwordx4 v2, s[60:63], s90 offen lds
    buffer_load_dwordx4 v3, s[60:63], s90 offen offset:1024 lds
    s_add_u32 s90, s90, 16384
    s_cmp_eq_u32 s90, s92
    s_cselect_b32 s90, s91, s90
    s_waitcnt vmcnt(16)
    s_nop 0
    ds_read_b64_tr_b16 v[80:81], v6 offset:16384
    ds_read_b64_tr_b16 v[82:83], v6 offset:16896
    ds_read_b64_tr_b16 v[84:85], v7 offset:16384
    ds_read_b64_tr_b16 v[86:87], v7 offset:16896
    s_waitcnt lgkmcnt(4)
    s_add_u32 m0, s98, 14336
    s_nop 0
    buffer_load_dwordx4 v2, s[60:63], s90 offen lds
    buffer_load_dwordx4 v3, s[60:63], s90 offen offset:1024 lds
    s_add_u32 s90, s90, 16384
    s_cmp_eq_u32 s90, s92
    s_cselect_b32 s90, s91, s90
    s_waitcnt vmcnt(16)
    s_nop 0
    ds_read_b64_tr_b16 v[88:89], v6 offset:18432
    ds_read_b64_tr_b16 v[90:91], v6 offset:18944
    ds_read_b64_tr_b16 v[92:93], v7 offset:18432
    ds_read_b64_tr_b16 v[94:95], v7 offset:18944
    s_waitcnt lgkmcnt(4)
    s_add_u32 m0, s98, 16384
    s_nop 0
    buffer_load_dwordx4 v2, s[60:63], s90 offen lds
    buffer_load_dwordx4 v3, s[60:63], s90 offen offset:1024 lds
    s_add_u32 s90, s90, 16384
    s_cmp_eq_u32 s90, s92
    s_cselect_b32 s90, s91, s90
    s_cmp_lg_u32 s68, 4
    s_cbranch_scc1 Lhl_31
    buffer_load_dword v249, v248, s[48:51], s85 offen sc1
Lhl_31:
    s_waitcnt vmcnt(16)
    s_nop 0
    ds_read_b64_tr_b16 v[96:97], v6 offset:0
    ds_read_b64_tr_b16 v[98:99], v6 offset:512
    ds_read_b64_tr_b16 v[100:101], v7 offset:0
    ds_read_b64_tr_b16 v[102:103], v7 offset:512
    s_waitcnt lgkmcnt(4)
    s_add_u32 m0, s98, 18432
    s_nop 0
    buffer_load_dwordx4 v2, s[60:63], s90 offen lds
    buffer_load_dwordx4 v3, s[60:63], s90 offen offset:1024 lds
    s_add_u32 s90, s90, 16384
    s_cmp_eq_u32 s90, s92
    s_cselect_b32 s90, s91, s90
    s_waitcnt vmcnt(16)
    s_nop 0
    ds_read_b64_tr_b16 v[104:105], v6 offset:2048
    ds_read_b64_tr_b16 v[106:107], v6 offset:2560
    ds_read_b64_tr_b16 v[108:109], v7 offset:2048
    ds_read_b64_tr_b16 v[110:111], v7 offset:2560
    s_waitcnt lgkmcnt(4)
    s_add_u32 m0, s98, 0
    s_nop 0
    s_nop 0
    buffer_load_dwordx4 v2, s[60:63], s90 offen lds
    buffer_load_dwordx4 v3, s[60:63], s90 offen offset:1024 lds
    s_add_u32 s90, s90, 16384
    s_cmp_eq_u32 s90, s92
    s_cselect_b32 s90, s91, s90
    s_waitcnt vmcnt(16)
    s_nop 0
    ds_read_b64_tr_b16 v[112:113], v6 offset:4096
    ds_read_b64_tr_b16 v[114:115], v6 offset:4608
    ds_read_b64_tr_b16 v[116:117], v7 offset:4096
    ds_read_b64_tr_b16 v[118:119], v7 offset:4608
    s_waitcnt lgkmcnt(4)
    s_add_u32 m0, s98, 2048
    s_nop 0
    buffer_load_dwordx4 v2, s[60:63], s90 offen lds
    buffer_load_dwordx4 v3, s[60:63], s90 offen offset:1024 lds
    s_add_u32 s90, s90, 16384
    s_cmp_eq_u32 s90, s92
    s_cselect_b32 s90, s91, s90
    s_waitcnt vmcnt(16)
    s_nop 0
    ds_read_b64_tr_b16 v[120:121], v6 offset:6144
    ds_read_b64_tr_b16 v[122:123], v6 offset:6656
    ds_read_b64_tr_b16 v[124:125], v7 offset:6144
    ds_read_b64_tr_b16 v[126:127], v7 offset:6656
    s_waitcnt lgkmcnt(4)
    s_add_u32 m0, s98, 4096
    s_nop 0
    buffer_load_dwordx4 v2, s[60:63], s90 offen lds
    buffer_load_dwordx4 v3, s[60:63], s90 offen offset:1024 lds
    s_add_u32 s90, s90, 16384
    s_cmp_eq_u32 s90, s92
    s_cselect_b32 s90, s91, s90
    s_waitcnt lgkmcnt(0)
    s_add_u32 m0, s98, 6144
    s_nop 0
    buffer_load_dwordx4 v2, s[60:63], s90 offen lds
    buffer_load_dwordx4 v3, s[60:63], s90 offen offset:1024 lds
    s_add_u32 s90, s90, 16384
    s_cmp_eq_u32 s90, s92
    s_cselect_b32 s90, s91, s90
    v_lshlrev_b32_e64 v128, 16, v240
    v_and_b32 v129, 0xffff0000, v240
    v_lshlrev_b32_e64 v130, 16, v241
    v_and_b32 v131, 0xffff0000, v241
    v_lshlrev_b32_e64 v132, 16, v242
    v_and_b32 v133, 0xffff0000, v242
    v_lshlrev_b32_e64 v134, 16, v243
    v_and_b32 v135, 0xffff0000, v243
    v_lshlrev_b32_e64 v136, 16, v244
    v_and_b32 v137, 0xffff0000, v244
    v_lshlrev_b32_e64 v138, 16, v245
    v_and_b32 v139, 0xffff0000, v245
    v_lshlrev_b32_e64 v140, 16, v246
    v_and_b32 v141, 0xffff0000, v246
    v_lshlrev_b32_e64 v142, 16, v247
    v_and_b32 v143, 0xffff0000, v247
    v_mov_b32 v14, 159844
    s_cmp_lg_u32 s68, 4
    s_cbranch_scc1 Lhw_32
    s_waitcnt vmcnt(0)
    v_cmp_ne_u32_e64 vcc, s99, v249
    s_mov_b32 s100, 0
    s_nop 0
    s_cmp_eq_u64 vcc, 0
    s_cbranch_scc1 Lfc_35
Lfp_36:
    s_sleep 8
    buffer_load_dword v249, v248, s[48:51], s85 offen sc1
    s_waitcnt vmcnt(0)
    v_cmp_ne_u32 vcc, s99, v249
    s_add_u32 s100, s100, 1
    s_nop 0
    s_cmp_eq_u64 vcc, 0
    s_cbranch_scc1 Lfc_35
    s_cmp_lt_u32 s100, 0x100000
    s_cbranch_scc1 Lfp_36
Lfc_35:
    v_mov_b32 v15, 1
    ds_write_b32 v14, v15
    s_branch Lhd_33
Lhw_32:
    s_mov_b32 s101, 0
Lhs_34:
    ds_read_b32 v15, v14
    s_add_u32 s101, s101, 1
    s_waitcnt lgkmcnt(0)
    v_readfirstlane_b32 s100, v15
    s_nop 0
    s_cmp_lg_u32 s100, 0
    s_cbranch_scc1 Lhd_33
    s_sleep 1
    s_cmp_lt_u32 s101, 0x1000000
    s_cbranch_scc1 Lhs_34
Lhd_33:
    buffer_load_dwordx4 v[192:195], v4, s[48:51], s93 offen sc1
    buffer_load_dwordx4 v[196:199], v5, s[48:51], s93 offen sc1
    s_add_u32 s93, s93, 1024
    s_cmp_eq_u32 s93, s97
    s_cselect_b32 s93, s95, s93
    buffer_load_dwordx4 v[200:203], v4, s[48:51], s93 offen sc1
    buffer_load_dwordx4 v[204:207], v5, s[48:51], s93 offen sc1
    s_add_u32 s93, s93, 1024
    s_cmp_eq_u32 s93, s97
    s_cselect_b32 s93, s95, s93
    buffer_load_dwordx4 v[208:211], v4, s[48:51], s93 offen sc1
    buffer_load_dwordx4 v[212:215], v5, s[48:51], s93 offen sc1
    s_add_u32 s93, s93, 1024
    s_cmp_eq_u32 s93, s97
    s_cselect_b32 s93, s95, s93
    buffer_load_dwordx4 v[216:219], v4, s[48:51], s93 offen sc1
    buffer_load_dwordx4 v[220:223], v5, s[48:51], s93 offen sc1
    s_add_u32 s93, s93, 1024
    s_cmp_eq_u32 s93, s97
    s_cselect_b32 s93, s95, s93
    buffer_load_dwordx4 v[224:227], v4, s[48:51], s93 offen sc1
    buffer_load_dwordx4 v[228:231], v5, s[48:51], s93 offen sc1
    s_add_u32 s93, s93, 1024
    s_cmp_eq_u32 s93, s97
    s_cselect_b32 s93, s95, s93
    buffer_load_dwordx4 v[232:235], v4, s[48:51], s93 offen sc1
    buffer_load_dwordx4 v[236:239], v5, s[48:51], s93 offen sc1
    s_add_u32 s93, s93, 1024
    s_cmp_eq_u32 s93, s97
    s_cselect_b32 s93, s95, s93
    buffer_load_dwordx4 v[240:243], v4, s[48:51], s93 offen sc1
    buffer_load_dwordx4 v[244:247], v5, s[48:51], s93 offen sc1
    s_add_u32 s93, s93, 1024
    s_cmp_eq_u32 s93, s97
    s_cselect_b32 s93, s95, s93
    buffer_load_dword v13, v9, s[48:51], s77 offen sc1
    v_and_b32 v248, 31, v0
    v_lshlrev_b32_e64 v248, 7, v248
    s_waitcnt vmcnt(13) lgkmcnt(0)
    v_mfma_f32_32x32x16_bf16 v[128:143], v[16:19], v[192:195], v[128:143]
    v_mfma_f32_32x32x16_bf16 v[144:159], v[16:19], v[196:199], 0
    v_mfma_f32_32x32x16_bf16 v[160:175], v[20:23], v[192:195], 0
    v_mfma_f32_32x32x16_bf16 v[176:191], v[20:23], v[196:199], 0
    s_waitcnt vmcnt(11) lgkmcnt(0)
    s_nop 0
    v_mfma_f32_32x32x16_bf16 v[128:143], v[24:27], v[200:203], v[128:143]
    buffer_load_dwordx4 v[192:195], v4, s[48:51], s93 offen sc1
    v_mfma_f32_32x32x16_bf16 v[144:159], v[24:27], v[204:207], v[144:159]
    buffer_load_dwordx4 v[196:199], v5, s[48:51], s93 offen sc1
    s_add_u32 s93, s93, 1024
    s_cmp_eq_u32 s93, s97
    s_cselect_b32 s93, s95, s93
    v_mfma_f32_32x32x16_bf16 v[160:175], v[28:31], v[200:203], v[160:175]
    buffer_load_dwordx4 v[16:19], v4, s[48:51], s93 offen sc1
    v_mfma_f32_32x32x16_bf16 v[176:191], v[28:31], v[204:207], v[176:191]
    buffer_load_dwordx4 v[20:23], v5, s[48:51], s93 offen sc1
    s_add_u32 s93, s93, 1024
    s_cmp_eq_u32 s93, s97
    s_cselect_b32 s93, s95, s93
    s_waitcnt vmcnt(13) lgkmcnt(0)
    s_nop 0
    v_mfma_f32_32x32x16_bf16 v[128:143], v[32:35], v[208:211], v[128:143]
    buffer_load_dwordx4 v[200:203], v4, s[48:51], s93 offen sc1
    v_mfma_f32_32x32x16_bf16 v[144:159], v[32:35], v[212:215], v[144:159]
    buffer_load_dwordx4 v[204:207], v5, s[48:51], s93 offen sc1
    s_add_u32 s93, s93, 1024
    s_cmp_eq_u32 s93, s97
    s_cselect_b32 s93, s95, s93
    v_mfma_f32_32x32x16_bf16 v[160:175], v[36:39], v[208:211], v[160:175]
    buffer_load_dwordx4 v[24:27], v4, s[48:51], s93 offen sc1
    v_mfma_f32_32x32x16_bf16 v[176:191], v[36:39], v[212:215], v[176:191]
    buffer_load_dwordx4 v[28:31], v5, s[48:51], s93 offen sc1
    s_add_u32 s93, s93, 1024
    s_cmp_eq_u32 s93, s97
    s_cselect_b32 s93, s95, s93
    s_waitcnt vmcnt(15) lgkmcnt(0)
    s_nop 0
    v_mfma_f32_32x32x16_bf16 v[128:143], v[40:43], v[216:219], v[128:143]
    buffer_load_dwordx4 v[208:211], v4, s[48:51], s93 offen sc1
    v_mfma_f32_32x32x16_bf16 v[144:159], v[40:43], v[220:223], v[144:159]
    buffer_load_dwordx4 v[212:215], v5, s[48:51], s93 offen sc1
    s_add_u32 s93, s93, 1024
    s_cmp_eq_u32 s93, s97
    s_cselect_b32 s93, s95, s93
    v_mfma_f32_32x32x16_bf16 v[160:175], v[44:47], v[216:219], v[160:175]
    buffer_load_dwordx4 v[32:35], v4, s[48:51], s93 offen sc1
    v_mfma_f32_32x32x16_bf16 v[176:191], v[44:47], v[220:223], v[176:191]
    buffer_load_dwordx4 v[36:39], v5, s[48:51], s93 offen sc1
    s_add_u32 s93, s93, 1024
    s_cmp_eq_u32 s93, s97
    s_cselect_b32 s93, s95, s93
    s_waitcnt vmcnt(17) lgkmcnt(0)
    s_nop 0
    v_mfma_f32_32x32x16_bf16 v[128:143], v[48:51], v[224:227], v[128:143]
    buffer_load_dwordx4 v[216:219], v4, s[48:51], s93 offen sc1
    v_mfma_f32_32x32x16_bf16 v[144:159], v[48:51], v[228:231], v[144:159]
    buffer_load_dwordx4 v[220:223], v5, s[48:51], s93 offen sc1
    s_add_u32 s93, s93, 1024
    s_cmp_eq_u32 s93, s97
    s_cselect_b32 s93, s95, s93
    v_mfma_f32_32x32x16_bf16 v[160:175], v[52:55], v[224:227], v[160:175]
    buffer_load_dwordx4 v[40:43], v4, s[48:51], s93 offen sc1
    v_mfma_f32_32x32x16_bf16 v[176:191], v[52:55], v[228:231], v[176:191]
    buffer_load_dwordx4 v[44:47], v5, s[48:51], s93 offen sc1
    s_add_u32 s93, s93, 1024
    s_cmp_eq_u32 s93, s97
    s_cselect_b32 s93, s95, s93
    s_waitcnt vmcnt(19) lgkmcnt(0)
    s_nop 0
    v_mfma_f32_32x32x16_bf16 v[128:143], v[56:59], v[232:235], v[128:143]
    buffer_load_dwordx4 v[224:227], v4, s[48:51], s93 offen sc1
    v_mfma_f32_32x32x16_bf16 v[144:159], v[56:59], v[236:239], v[144:159]
    buffer_load_dwordx4 v[228:231], v5, s[48:51], s93 offen sc1
    s_add_u32 s93, s93, 1024
    s_cmp_eq_u32 s93, s97
    s_cselect_b32 s93, s95, s93
    v_mfma_f32_32x32x16_bf16 v[160:175], v[60:63], v[232:235], v[160:175]
    v_mfma_f32_32x32x16_bf16 v[176:191], v[60:63], v[236:239], v[176:191]
    s_waitcnt vmcnt(19) lgkmcnt(0)
    s_nop 0
    v_mfma_f32_32x32x16_bf16 v[128:143], v[64:67], v[240:243], v[128:143]
    buffer_load_dwordx4 v[48:51], v4, s[48:51], s93 offen sc1
    v_mfma_f32_32x32x16_bf16 v[144:159], v[64:67], v[244:247], v[144:159]
    buffer_load_dwordx4 v[52:55], v5, s[48:51], s93 offen sc1
    s_add_u32 s93, s93, 1024
    s_cmp_eq_u32 s93, s97
    s_cselect_b32 s93, s95, s93
    v_mfma_f32_32x32x16_bf16 v[160:175], v[68:71], v[240:243], v[160:175]
    v_mfma_f32_32x32x16_bf16 v[176:191], v[68:71], v[244:247], v[176:191]
    s_waitcnt vmcnt(18) lgkmcnt(0)
    s_nop 0
    v_mfma_f32_32x32x16_bf16 v[128:143], v[72:75], v[192:195], v[128:143]
    buffer_load_dwordx4 v[232:235], v4, s[48:51], s93 offen sc1
    v_mfma_f32_32x32x16_bf16 v[144:159], v[72:75], v[196:199], v[144:159]
    buffer_load_dwordx4 v[236:239], v5, s[48:51], s93 offen sc1
    s_add_u32 s93, s93, 1024
    s_cmp_eq_u32 s93, s97
    s_cselect_b32 s93, s95, s93
    v_mfma_f32_32x32x16_bf16 v[160:175], v[76:79], v[192:195], v[160:175]
    v_mfma_f32_32x32x16_bf16 v[176:191], v[76:79], v[196:199], v[176:191]
    s_waitcnt vmcnt(18) lgkmcnt(0)
    s_nop 0
    v_mfma_f32_32x32x16_bf16 v[128:143], v[80:83], v[16:19], v[128:143]
    buffer_load_dwordx4 v[56:59], v4, s[48:51], s93 offen sc1
    v_mfma_f32_32x32x16_bf16 v[144:159], v[80:83], v[20:23], v[144:159]
    buffer_load_dwordx4 v[60:63], v5, s[48:51], s93 offen sc1
    s_add_u32 s93, s93, 1024
    s_cmp_eq_u32 s93, s97
    s_cselect_b32 s93, s95, s93
    v_mfma_f32_32x32x16_bf16 v[160:175], v[84:87], v[16:19], v[160:175]
    v_mfma_f32_32x32x16_bf16 v[176:191], v[84:87], v[20:23], v[176:191]
    s_waitcnt vmcnt(18) lgkmcnt(0)
    s_nop 0
    v_mfma_f32_32x32x16_bf16 v[128:143], v[88:91], v[200:203], v[128:143]
    buffer_load_dwordx4 v[240:243], v4, s[48:51], s93 offen sc1
    v_mfma_f32_32x32x16_bf16 v[144:159], v[88:91], v[204:207], v[144:159]
    buffer_load_dwordx4 v[244:247], v5, s[48:51], s93 offen sc1
    s_add_u32 s93, s93, 1024
    s_cmp_eq_u32 s93, s97
    s_cselect_b32 s93, s95, s93
    v_mfma_f32_32x32x16_bf16 v[160:175], v[92:95], v[200:203], v[160:175]
    v_mfma_f32_32x32x16_bf16 v[176:191], v[92:95], v[204:207], v[176:191]
    s_waitcnt vmcnt(18) lgkmcnt(0)
    s_nop 0
    v_mfma_f32_32x32x16_bf16 v[128:143], v[96:99], v[24:27], v[128:143]
    buffer_load_dwordx4 v[64:67], v4, s[48:51], s93 offen sc1
    v_mfma_f32_32x32x16_bf16 v[144:159], v[96:99], v[28:31], v[144:159]
    buffer_load_dwordx4 v[68:71], v5, s[48:51], s93 offen sc1
    s_add_u32 s93, s93, 1024
    s_cmp_eq_u32 s93, s97
    s_cselect_b32 s93, s95, s93
    v_mfma_f32_32x32x16_bf16 v[160:175], v[100:103], v[24:27], v[160:175]
    v_mfma_f32_32x32x16_bf16 v[176:191], v[100:103], v[28:31], v[176:191]
    s_waitcnt vmcnt(18) lgkmcnt(0)
    s_nop 0
    v_mfma_f32_32x32x16_bf16 v[128:143], v[104:107], v[208:211], v[128:143]
    buffer_load_dwordx4 v[192:195], v4, s[48:51], s93 offen sc1
    v_mfma_f32_32x32x16_bf16 v[144:159], v[104:107], v[212:215], v[144:159]
    buffer_load_dwordx4 v[196:199], v5, s[48:51], s93 offen sc1
    s_add_u32 s93, s93, 1024
    s_cmp_eq_u32 s93, s97
    s_cselect_b32 s93, s95, s93
    v_mfma_f32_32x32x16_bf16 v[160:175], v[108:111], v[208:211], v[160:175]
    v_mfma_f32_32x32x16_bf16 v[176:191], v[108:111], v[212:215], v[176:191]
    s_waitcnt vmcnt(18) lgkmcnt(0)
    s_nop 0
    v_mfma_f32_32x32x16_bf16 v[128:143], v[112:115], v[32:35], v[128:143]
    buffer_load_dwordx4 v[72:75], v4, s[48:51], s93 offen sc1
    v_mfma_f32_32x32x16_bf16 v[144:159], v[112:115], v[36:39], v[144:159]
    buffer_load_dwordx4 v[76:79], v5, s[48:51], s93 offen sc1
    s_add_u32 s93, s93, 1024
    s_cmp_eq_u32 s93, s97
    s_cselect_b32 s93, s95, s93
    v_mfma_f32_32x32x16_bf16 v[160:175], v[116:119], v[32:35], v[160:175]
    v_mfma_f32_32x32x16_bf16 v[176:191], v[116:119], v[36:39], v[176:191]
    s_waitcnt vmcnt(18) lgkmcnt(0)
    s_nop 0
    v_mfma_f32_32x32x16_bf16 v[128:143], v[120:123], v[216:219], v[128:143]
    buffer_load_dwordx4 v[80:83], v4, s[48:51], s93 offen sc1
    v_mfma_f32_32x32x16_bf16 v[144:159], v[120:123], v[220:223], v[144:159]
    buffer_load_dwordx4 v[84:87], v5, s[48:51], s93 offen sc1
    s_add_u32 s93, s93, 1024
    s_cmp_eq_u32 s93, s97
    s_cselect_b32 s93, s95, s93
    v_mfma_f32_32x32x16_bf16 v[160:175], v[124:127], v[216:219], v[160:175]
    ds_read_b64_tr_b16 v[16:17], v6 offset:8192
    v_mfma_f32_32x32x16_bf16 v[176:191], v[124:127], v[220:223], v[176:191]
    ds_read_b64_tr_b16 v[18:19], v6 offset:8704
    ds_read_b64_tr_b16 v[20:21], v7 offset:8192
    ds_read_b64_tr_b16 v[22:23], v7 offset:8704
    s_waitcnt vmcnt(18) lgkmcnt(0)
    s_nop 0
    v_mfma_f32_32x32x16_bf16 v[128:143], v[16:19], v[40:43], v[128:143]
    buffer_load_dwordx4 v[88:91], v4, s[48:51], s93 offen sc1
    v_mfma_f32_32x32x16_bf16 v[144:159], v[16:19], v[44:47], v[144:159]
    buffer_load_dwordx4 v[92:95], v5, s[48:51], s93 offen sc1
    s_add_u32 s93, s93, 1024
    s_cmp_eq_u32 s93, s97
    s_cselect_b32 s93, s95, s93
    v_mfma_f32_32x32x16_bf16 v[160:175], v[20:23], v[40:43], v[160:175]
    ds_read_b64_tr_b16 v[200:201], v6 offset:10240
    v_mfma_f32_32x32x16_bf16 v[176:191], v[20:23], v[44:47], v[176:191]
    ds_read_b64_tr_b16 v[202:203], v6 offset:10752
    ds_read_b64_tr_b16 v[204:205], v7 offset:10240
    ds_read_b64_tr_b16 v[206:207], v7 offset:10752
    buffer_load_dword v249, v248, s[48:51], s83 offen sc1
    s_waitcnt vmcnt(19) lgkmcnt(0)
    s_nop 0
    v_mfma_f32_32x32x16_bf16 v[128:143], v[200:203], v[224:227], v[128:143]
    buffer_load_dwordx4 v[96:99], v4, s[48:51], s93 offen sc1
    v_mfma_f32_32x32x16_bf16 v[144:159], v[200:203], v[228:231], v[144:159]
    buffer_load_dwordx4 v[100:103], v5, s[48:51], s93 offen sc1
    s_add_u32 s93, s93, 1024
    s_cmp_eq_u32 s93, s97
    s_cselect_b32 s93, s95, s93
    v_mfma_f32_32x32x16_bf16 v[160:175], v[204:207], v[224:227], v[160:175]
    s_add_u32 m0, s98, 8192
    s_nop 0
    s_nop 0
    buffer_load_dwordx4 v2, s[60:63], s90 offen lds
    buffer_load_dwordx4 v3, s[60:63], s90 offen offset:1024 lds
    s_add_u32 s90, s90, 16384
    s_cmp_eq_u32 s90, s92
    s_cselect_b32 s90, s91, s90
    v_mfma_f32_32x32x16_bf16 v[176:191], v[204:207], v[228:231], v[176:191]
    ds_read_b64_tr_b16 v[24:25], v6 offset:12288
    ds_read_b64_tr_b16 v[26:27], v6 offset:12800
    ds_read_b64_tr_b16 v[28:29], v7 offset:12288
    ds_read_b64_tr_b16 v[30:31], v7 offset:12800
    s_waitcnt vmcnt(21) lgkmcnt(0)
    s_nop 0
    v_mfma_f32_32x32x16_bf16 v[128:143], v[24:27], v[48:51], v[128:143]
    buffer_load_dwordx4 v[104:107], v4, s[48:51], s93 offen sc1
    v_mfma_f32_32x32x16_bf16 v[144:159], v[24:27], v[52:55], v[144:159]
    buffer_load_dwordx4 v[108:111], v5, s[48:51], s93 offen sc1
    s_add_u32 s93, s93, 1024
    s_cmp_eq_u32 s93, s97
    s_cselect_b32 s93, s95, s93
    v_mfma_f32_32x32x16_bf16 v[160:175], v[28:31], v[48:51], v[160:175]
    s_add_u32 m0, s98, 10240
    s_nop 0
    s_nop 0
    buffer_load_dwordx4 v2, s[60:63], s90 offen lds
    buffer_load_dwordx4 v3, s[60:63], s90 offen offset:1024 lds
    s_add_u32 s90, s90, 16384
    s_cmp_eq_u32 s90, s92
    s_cselect_b32 s90, s91, s90
    v_mfma_f32_32x32x16_bf16 v[176:191], v[28:31], v[52:55], v[176:191]
    ds_read_b64_tr_b16 v[208:209], v6 offset:14336
    ds_read_b64_tr_b16 v[210:211], v6 offset:14848
    ds_read_b64_tr_b16 v[212:213], v7 offset:14336
    ds_read_b64_tr_b16 v[214:215], v7 offset:14848
    s_waitcnt vmcnt(23) lgkmcnt(0)
    s_nop 0
    v_mfma_f32_32x32x16_bf16 v[128:143], v[208:211], v[232:235], v[128:143]
    buffer_load_dwordx4 v[112:115], v4, s[48:51], s93 offen sc1
    v_mfma_f32_32x32x16_bf16 v[144:159], v[208:211], v[236:239], v[144:159]
    buffer_load_dwordx4 v[116:119], v5, s[48:51], s93 offen sc1
    s_add_u32 s93, s93, 1024
    s_cmp_eq_u32 s93, s97
    s_cselect_b32 s93, s95, s93
    v_mfma_f32_32x32x16_bf16 v[160:175], v[212:215], v[232:235], v[160:175]
    s_add_u32 m0, s98, 12288
    s_nop 0
    s_nop 0
    buffer_load_dwordx4 v2, s[60:63], s90 offen lds
    buffer_load_dwordx4 v3, s[60:63], s90 offen offset:1024 lds
    s_add_u32 s90, s90, 16384
    s_cmp_eq_u32 s90, s92
    s_cselect_b32 s90, s91, s90
    v_mfma_f32_32x32x16_bf16 v[176:191], v[212:215], v[236:239], v[176:191]
    ds_read_b64_tr_b16 v[32:33], v6 offset:16384
    ds_read_b64_tr_b16 v[34:35], v6 offset:16896
    ds_read_b64_tr_b16 v[36:37], v7 offset:16384
    ds_read_b64_tr_b16 v[38:39], v7 offset:16896
    s_waitcnt vmcnt(25) lgkmcnt(0)
    v_mfma_f32_32x32x16_bf16 v[128:143], v[32:35], v[56:59], v[128:143]
    s_add_u32 m0, s98, 14336
    s_nop 0
    buffer_load_dwordx4 v2, s[60:63], s90 offen lds
    buffer_load_dwordx4 v3, s[60:63], s90 offen offset:1024 lds
    s_add_u32 s90, s90, 16384
    s_cmp_eq_u32 s90, s92
    s_cselect_b32 s90, s91, s90
    v_mfma_f32_32x32x16_bf16 v[144:159], v[32:35], v[60:63], v[144:159]
    ds_read_b64_tr_b16 v[216:217], v6 offset:18432
    v_mfma_f32_32x32x16_bf16 v[160:175], v[36:39], v[56:59], v[160:175]
    ds_read_b64_tr_b16 v[218:219], v6 offset:18944
    v_mfma_f32_32x32x16_bf16 v[176:191], v[36:39], v[60:63], v[176:191]
    ds_read_b64_tr_b16 v[220:221], v7 offset:18432
    ds_read_b64_tr_b16 v[222:223], v7 offset:18944
    s_waitcnt vmcnt(25) lgkmcnt(0)
    s_nop 0
    v_mfma_f32_32x32x16_bf16 v[128:143], v[216:219], v[240:243], v[128:143]
    ds_read_b64_tr_b16 v[120:121], v6 offset:0
    v_mfma_f32_32x32x16_bf16 v[144:159], v[216:219], v[244:247], v[144:159]
    ds_read_b64_tr_b16 v[122:123], v6 offset:512
    v_mfma_f32_32x32x16_bf16 v[160:175], v[220:223], v[240:243], v[160:175]
    ds_read_b64_tr_b16 v[124:125], v7 offset:0
    v_mfma_f32_32x32x16_bf16 v[176:191], v[220:223], v[244:247], v[176:191]
    ds_read_b64_tr_b16 v[126:127], v7 offset:512
    s_waitcnt vmcnt(23) lgkmcnt(0)
    s_nop 0
    v_mfma_f32_32x32x16_bf16 v[128:143], v[120:123], v[64:67], v[128:143]
    ds_read_b64_tr_b16 v[40:41], v6 offset:2048
    v_mfma_f32_32x32x16_bf16 v[144:159], v[120:123], v[68:71], v[144:159]
    ds_read_b64_tr_b16 v[42:43], v6 offset:2560
    v_mfma_f32_32x32x16_bf16 v[160:175], v[124:127], v[64:67], v[160:175]
    ds_read_b64_tr_b16 v[44:45], v7 offset:2048
    v_mfma_f32_32x32x16_bf16 v[176:191], v[124:127], v[68:71], v[176:191]
    ds_read_b64_tr_b16 v[46:47], v7 offset:2560
    s_waitcnt vmcnt(14) lgkmcnt(0)
    v_cmp_ne_u32 vcc, s99, v249
    v_mfma_f32_32x32x16_bf16 v[128:143], v[40:43], v[192:195], v[128:143]
    ds_read_b64_tr_b16 v[16:17], v6 offset:4096
    v_mfma_f32_32x32x16_bf16 v[144:159], v[40:43], v[196:199], v[144:159]
    ds_read_b64_tr_b16 v[18:19], v6 offset:4608
    v_mfma_f32_32x32x16_bf16 v[160:175], v[44:47], v[192:195], v[160:175]
    ds_read_b64_tr_b16 v[20:21], v7 offset:4096
    v_mfma_f32_32x32x16_bf16 v[176:191], v[44:47], v[196:199], v[176:191]
    ds_read_b64_tr_b16 v[22:23], v7 offset:4608
    s_cmp_eq_u64 vcc, 0
    s_cselect_b32 s94, 1, 0
    s_cbranch_scc0 Lnr_37
    s_nop 0
    buffer_load_dwordx4 v[224:227], v8, s[48:51], s76 offen sc1
    s_add_u32 s73, s76, 65536
    buffer_load_dwordx4 v[228:231], v8, s[48:51], s73 offen sc1
Lnr_37:
    s_waitcnt vmcnt(19) lgkmcnt(0)
    s_nop 0
    v_mfma_f32_32x32x16_bf16 v[128:143], v[16:19], v[72:75], v[128:143]
    ds_read_b64_tr_b16 v[200:201], v6 offset:6144
    v_mfma_f32_32x32x16_bf16 v[144:159], v[16:19], v[76:79], v[144:159]
    ds_read_b64_tr_b16 v[202:203], v6 offset:6656
    v_mfma_f32_32x32x16_bf16 v[160:175], v[20:23], v[72:75], v[160:175]
    ds_read_b64_tr_b16 v[204:205], v7 offset:6144
    v_mfma_f32_32x32x16_bf16 v[176:191], v[20:23], v[76:79], v[176:191]
    ds_read_b64_tr_b16 v[206:207], v7 offset:6656
    s_waitcnt vmcnt(10) lgkmcnt(0)
    s_nop 0
    v_mfma_f32_32x32x16_bf16 v[128:143], v[200:203], v[80:83], v[128:143]
    ds_read_b64_tr_b16 v[48:49], v6 offset:8192
    v_mfma_f32_32x32x16_bf16 v[144:159], v[200:203], v[84:87], v[144:159]
    ds_read_b64_tr_b16 v[50:51], v6 offset:8704
    v_mfma_f32_32x32x16_bf16 v[160:175], v[204:207], v[80:83], v[160:175]
    ds_read_b64_tr_b16 v[52:53], v7 offset:8192
    v_mfma_f32_32x32x16_bf16 v[176:191], v[204:207], v[84:87], v[176:191]
    ds_read_b64_tr_b16 v[54:55], v7 offset:8704
    s_waitcnt vmcnt(6) lgkmcnt(0)
    s_nop 0
    v_mfma_f32_32x32x16_bf16 v[128:143], v[48:51], v[88:91], v[128:143]
    ds_read_b64_tr_b16 v[24:25], v6 offset:10240
    v_mfma_f32_32x32x16_bf16 v[144:159], v[48:51], v[92:95], v[144:159]
    ds_read_b64_tr_b16 v[26:27], v6 offset:10752
    v_mfma_f32_32x32x16_bf16 v[160:175], v[52:55], v[88:91], v[160:175]
    ds_read_b64_tr_b16 v[28:29], v7 offset:10240
    v_mfma_f32_32x32x16_bf16 v[176:191], v[52:55], v[92:95], v[176:191]
    ds_read_b64_tr_b16 v[30:31], v7 offset:10752
    s_waitcnt vmcnt(2) lgkmcnt(0)
    s_nop 0
    v_mfma_f32_32x32x16_bf16 v[128:143], v[24:27], v[96:99], v[128:143]
    ds_read_b64_tr_b16 v[232:233], v6 offset:12288
    v_mfma_f32_32x32x16_bf16 v[144:159], v[24:27], v[100:103], v[144:159]
    ds_read_b64_tr_b16 v[234:235], v6 offset:12800
    v_mfma_f32_32x32x16_bf16 v[160:175], v[28:31], v[96:99], v[160:175]
    ds_read_b64_tr_b16 v[236:237], v7 offset:12288
    v_mfma_f32_32x32x16_bf16 v[176:191], v[28:31], v[100:103], v[176:191]
    ds_read_b64_tr_b16 v[238:239], v7 offset:12800
    s_waitcnt vmcnt(0) lgkmcnt(0)
    s_nop 0
    v_mfma_f32_32x32x16_bf16 v[128:143], v[232:235], v[104:107], v[128:143]
    ds_read_b64_tr_b16 v[208:209], v6 offset:14336
    v_mfma_f32_32x32x16_bf16 v[144:159], v[232:235], v[108:111], v[144:159]
    ds_read_b64_tr_b16 v[210:211], v6 offset:14848
    v_mfma_f32_32x32x16_bf16 v[160:175], v[236:239], v[104:107], v[160:175]
    ds_read_b64_tr_b16 v[212:213], v7 offset:14336
    v_mfma_f32_32x32x16_bf16 v[176:191], v[236:239], v[108:111], v[176:191]
    ds_read_b64_tr_b16 v[214:215], v7 offset:14848
    s_waitcnt vmcnt(4) lgkmcnt(0)
    s_nop 0
    v_mfma_f32_32x32x16_bf16 v[128:143], v[208:211], v[112:115], v[128:143]
    v_mfma_f32_32x32x16_bf16 v[144:159], v[208:211], v[116:119], v[144:159]
    v_mfma_f32_32x32x16_bf16 v[160:175], v[212:215], v[112:115], v[160:175]
    v_mfma_f32_32x32x16_bf16 v[176:191], v[212:215], v[116:119], v[176:191]
    s_waitcnt lgkmcnt(0)
    s_barrier
    v_lshlrev_b32 v14, 4, v0
    s_xor_b32 s73, s96, 1
    s_lshl_b32 s73, s73, 14
    v_add_u32 v2, s73, v14
    s_xor_b32 s73, s96, 2
    s_lshl_b32 s73, s73, 14
    v_add_u32 v3, s73, v14
    s_xor_b32 s73, s96, 3
    s_lshl_b32 s73, s73, 14
    v_add_u32_e64 v4, s73, v14
    s_nop 4
    ds_write_b128 v2, v[144:147] offset:4096
    ds_write_b128 v2, v[148:151] offset:5120
    ds_write_b128 v2, v[152:155] offset:6144
    ds_write_b128 v2, v[156:159] offset:7168
    ds_write_b128 v3, v[160:163] offset:8192
    ds_write_b128 v3, v[164:167] offset:9216
    ds_write_b128 v3, v[168:171] offset:10240
    ds_write_b128 v3, v[172:175] offset:11264
    ds_write_b128 v4, v[176:179] offset:12288
    ds_write_b128 v4, v[180:183] offset:13312
    ds_write_b128 v4, v[184:187] offset:14336
    ds_write_b128 v4, v[188:191] offset:15360
    s_cmp_eq_u32 s94, 1
    s_cbranch_scc1 Lback_38
    buffer_load_dword v249, v248, s[48:51], s83 offen sc1
    s_waitcnt vmcnt(0)
    v_cmp_ne_u32_e64 vcc, s99, v249
    s_mov_b32 s100, 0
    s_nop 0
    s_cmp_eq_u64 vcc, 0
    s_cbranch_scc1 Lfc_39
Lfp_40:
    s_sleep 8
    buffer_load_dword v249, v248, s[48:51], s83 offen sc1
    s_waitcnt vmcnt(0)
    v_cmp_ne_u32 vcc, s99, v249
    s_add_u32 s100, s100, 1
    s_nop 0
    s_cmp_eq_u64 vcc, 0
    s_cbranch_scc1 Lfc_39
    s_cmp_lt_u32 s100, 0x100000
    s_cbranch_scc1 Lfp_40
Lfc_39:
    s_nop 0
    buffer_load_dwordx4 v[224:227], v8, s[48:51], s76 offen sc1
    s_add_u32 s73, s76, 65536
    buffer_load_dwordx4 v[228:231], v8, s[48:51], s73 offen sc1
Lback_38:
    s_waitcnt vmcnt(0)
    ds_write_b128 v11, v[224:227]
    ds_write_b128 v11, v[228:231] offset:1280
    s_lshl_b32 s73, s96, 14
    v_add_u32 v5, s73, v14
    v_sub_f32 v18, 1.0, v13
    v_cvt_pk_bf16_f32 v18, v18, v18
    v_and_b32 v18, 0xffff0000, v18
    v_mov_b32 v16, v13
    v_mov_b32 v17, v13
    v_mov_b32_e64 v19, v18
    s_waitcnt lgkmcnt(0)
    s_barrier
    ds_read_b64_tr_b16 v[24:25], v12 offset:0
    ds_read_b64_tr_b16 v[26:27], v12 offset:320
    ds_read_b64_tr_b16 v[28:29], v12 offset:1280
    ds_read_b64_tr_b16 v[30:31], v12 offset:1600
    ds_read_b128 v[64:67], v5 offset:4096
    ds_read_b128 v[68:71], v5 offset:5120
    ds_read_b128 v[72:75], v5 offset:6144
    ds_read_b128 v[76:79], v5 offset:7168
    ds_read_b128 v[80:83], v5 offset:8192
    ds_read_b128 v[84:87], v5 offset:9216
    ds_read_b128 v[88:91], v5 offset:10240
    ds_read_b128 v[92:95], v5 offset:11264
    ds_read_b128 v[96:99], v5 offset:12288
    ds_read_b128 v[100:103], v5 offset:13312
    ds_read_b128 v[104:107], v5 offset:14336
    ds_read_b128 v[108:111], v5 offset:15360
    s_waitcnt lgkmcnt(8)
    s_nop 0
    v_pk_add_f32 v[128:129], v[128:129], v[64:65]
    v_pk_add_f32 v[130:131], v[130:131], v[66:67]
    v_pk_add_f32 v[132:133], v[132:133], v[68:69]
    v_pk_add_f32 v[134:135], v[134:135], v[70:71]
    v_pk_add_f32 v[136:137], v[136:137], v[72:73]
    v_pk_add_f32 v[138:139], v[138:139], v[74:75]
    v_pk_add_f32 v[140:141], v[140:141], v[76:77]
    v_pk_add_f32 v[142:143], v[142:143], v[78:79]
    s_waitcnt lgkmcnt(4)
    s_nop 0
    v_pk_add_f32 v[128:129], v[128:129], v[80:81]
    v_pk_add_f32 v[130:131], v[130:131], v[82:83]
    v_pk_add_f32 v[132:133], v[132:133], v[84:85]
    v_pk_add_f32 v[134:135], v[134:135], v[86:87]
    v_pk_add_f32 v[136:137], v[136:137], v[88:89]
    v_pk_add_f32 v[138:139], v[138:139], v[90:91]
    v_pk_add_f32 v[140:141], v[140:141], v[92:93]
    v_pk_add_f32 v[142:143], v[142:143], v[94:95]
    s_waitcnt lgkmcnt(0)
    s_nop 0
    v_pk_add_f32 v[128:129], v[128:129], v[96:97]
    v_pk_add_f32 v[130:131], v[130:131], v[98:99]
    v_pk_add_f32 v[132:133], v[132:133], v[100:101]
    v_pk_add_f32 v[134:135], v[134:135], v[102:103]
    v_pk_add_f32 v[136:137], v[136:137], v[104:105]
    v_pk_add_f32 v[138:139], v[138:139], v[106:107]
    v_pk_add_f32 v[140:141], v[140:141], v[108:109]
    v_pk_add_f32 v[142:143], v[142:143], v[110:111]
    v_lshlrev_b32_e64 v40, 16, v24
    v_and_b32 v41, 0xffff0000, v24
    v_pk_mul_f32 v[128:129], v[128:129], v[18:19]
    v_pk_fma_f32 v[128:129], v[40:41], v[16:17], v[128:129]
    v_cvt_pk_bf16_f32 v32, v128, v129
    v_lshlrev_b32_e64 v42, 16, v25
    v_and_b32 v43, 0xffff0000, v25
    v_pk_mul_f32 v[130:131], v[130:131], v[18:19]
    v_pk_fma_f32 v[130:131], v[42:43], v[16:17], v[130:131]
    v_cvt_pk_bf16_f32 v33, v130, v131
    v_lshlrev_b32_e64 v40, 16, v26
    v_and_b32 v41, 0xffff0000, v26
    v_pk_mul_f32 v[132:133], v[132:133], v[18:19]
    v_pk_fma_f32 v[132:133], v[40:41], v[16:17], v[132:133]
    v_cvt_pk_bf16_f32 v34, v132, v133
    v_lshlrev_b32_e64 v42, 16, v27
    v_and_b32 v43, 0xffff0000, v27
    v_pk_mul_f32 v[134:135], v[134:135], v[18:19]
    v_pk_fma_f32 v[134:135], v[42:43], v[16:17], v[134:135]
    v_cvt_pk_bf16_f32 v35, v134, v135
    buffer_store_dwordx4 v[32:35], v10, s[64:67], s78 offen
    v_lshlrev_b32_e64 v40, 16, v28
    v_and_b32 v41, 0xffff0000, v28
    v_pk_mul_f32 v[136:137], v[136:137], v[18:19]
    v_pk_fma_f32 v[136:137], v[40:41], v[16:17], v[136:137]
    v_cvt_pk_bf16_f32 v36, v136, v137
    v_lshlrev_b32_e64 v42, 16, v29
    v_and_b32 v43, 0xffff0000, v29
    v_pk_mul_f32 v[138:139], v[138:139], v[18:19]
    v_pk_fma_f32 v[138:139], v[42:43], v[16:17], v[138:139]
    v_cvt_pk_bf16_f32 v37, v138, v139
    v_lshlrev_b32_e64 v40, 16, v30
    v_and_b32 v41, 0xffff0000, v30
    v_pk_mul_f32 v[140:141], v[140:141], v[18:19]
    v_pk_fma_f32 v[140:141], v[40:41], v[16:17], v[140:141]
    v_cvt_pk_bf16_f32 v38, v140, v141
    v_lshlrev_b32_e64 v42, 16, v31
    v_and_b32 v43, 0xffff0000, v31
    v_pk_mul_f32 v[142:143], v[142:143], v[18:19]
    v_pk_fma_f32 v[142:143], v[42:43], v[16:17], v[142:143]
    v_cvt_pk_bf16_f32 v39, v142, v143
    buffer_store_dwordx4 v[36:39], v10, s[64:67], s78 offen offset:32
    s_endpgm
L_end:
    s_endpgm
.section .rodata,"a"
.p2align 6
.amdhsa_kernel gated_mix__ssm_conv_s4__dense_activation_squared_relu__prompt_kernel
  .amdhsa_next_free_vgpr 256
  .amdhsa_next_free_sgpr 102
  .amdhsa_accum_offset 256
  .amdhsa_group_segment_fixed_size 0
  .amdhsa_kernarg_size 144
  .amdhsa_user_sgpr_count 2
  .amdhsa_user_sgpr_kernarg_segment_ptr 1
  .amdhsa_system_sgpr_workgroup_id_x 1
.end_amdhsa_kernel
```
